```python
import torch

def _softmax(x, axis=-1):
    return torch.softmax(x, dim=axis)
def _gelu(x):
    return torch.nn.functional.gelu(x, approximate="tanh")
def _silu(x):
    return torch.nn.functional.silu(x)
def _sigmoid(x):
    return torch.sigmoid(x)
def _layernorm(x, axis=-1, eps=1e-5):
    m = x.mean(dim=axis, keepdim=True)
    v = x.var(dim=axis, keepdim=True, unbiased=False)
    return (x - m) / torch.sqrt(v + eps)
def _scatter_add(tgt, idx, src, axis=0):
    return tgt.clone().index_add_(axis, idx, src)
def _segment_sum(src, seg, n):
    out = torch.zeros((n,) + src.shape[1:], dtype=src.dtype)
    return out.index_add_(0, seg, src)
def _pad(x, pw):
    flat = tuple(v for pair in reversed(pw) for v in pair)
    return torch.nn.functional.pad(x, flat)

kernel_name = 'gated_mix__mha_block_cached__glu_gated_swiglu__decode'

def setup_inputs():

    _w = (lambda a: (lambda t: t.to(torch.bfloat16) if t.is_floating_point() else t)(torch.as_tensor(a)))
    def _A_setup():
        B, Sq, D = 4, 1, 640
        H, Sk, Dh = 32, 8192, 192
        return {
            "x": _w((lambda *s: torch.randn(*s, dtype=torch.bfloat16) * 0.05)(B, Sq, D)),
            "k_cache": _w((lambda *s: torch.randn(*s, dtype=torch.bfloat16) * 6.4)(B, H, Sk, Dh)),
            "v_cache": _w((lambda *s: torch.randn(*s, dtype=torch.bfloat16) * 0.05)(B, H, Sk, Dh)),
            "wq": _w((lambda *s: torch.randn(*s, dtype=torch.bfloat16) * 6.4)(D, H * Dh) * (D ** -0.5)),
            "wo": _w((lambda *s: torch.randn(*s, dtype=torch.bfloat16) * 0.05)(H * Dh, D) * ((H * Dh) ** -0.5)),
        }
    _A_in = _A_setup()

    def _B_setup():
        B, S, D, F = 4, 1, 640, 1536
        return {
            "x": _w((lambda *s: torch.randn(*s, dtype=torch.bfloat16) * 0.05)(B, S, D)),
            "w1": _w((lambda *s: torch.randn(*s, dtype=torch.bfloat16) * 0.4)(D, F) * (2.0 / D) ** 0.5),
            "w3": _w((lambda *s: torch.randn(*s, dtype=torch.bfloat16) * 0.4)(D, F) * (2.0 / D) ** 0.5),
            "w2": _w((lambda *s: torch.randn(*s, dtype=torch.bfloat16) * 0.4)(F, D) * (2.0 / F) ** 0.5),
        }
    _B_in = _B_setup()

    return {
        "A_x": _A_in["x"],
        "A_k_cache": _A_in["k_cache"],
        "A_v_cache": _A_in["v_cache"],
        "A_wq": _A_in["wq"],
        "A_wo": _A_in["wo"],
        "B_x": _B_in["x"],
        "B_w1": _B_in["w1"],
        "B_w3": _B_in["w3"],
        "B_w2": _B_in["w2"],
        "gate_w": _w((lambda *s: torch.randn(*s, dtype=torch.bfloat16) * 0.05)(640) * 16.0),
    }

def reference(A_x, A_k_cache, A_v_cache, A_wq, A_wo, B_x, B_w1, B_w3, B_w2, gate_w):
    def _A_ref(x, k_cache, v_cache, wq, wo):
        B, Sq, D = x.shape
        H, Dh = 32, 192
        q = (lambda x, *d: x.permute(*d))((x @ wq).reshape(B, Sq, H, Dh), 0, 2, 1, 3)
        scores = torch.einsum("bhqd,bhkd->bhqk", q, k_cache) * (Dh ** -0.5)
        p = _softmax(scores, axis=-1)
        o = torch.einsum("bhqk,bhkd->bhqd", p, v_cache)
        return (lambda x, *d: x.permute(*d))(o, 0, 2, 1, 3).reshape(B, Sq, H * Dh) @ wo

    def _B_ref(x, w1, w3, w2):
        gate = torch.einsum("bsd,df->bsf", x, w1)
        up = torch.einsum("bsd,df->bsf", x, w3)
        h = _silu(gate) * up
        out = torch.einsum("bsf,fd->bsd", h, w2)
        return out

    x = A_x
    g = _sigmoid((x * gate_w).sum(-1, keepdims=True))
    a = _A_ref(x, A_k_cache, A_v_cache, A_wq, A_wo)
    b = _B_ref(x, B_w1, B_w3, B_w2)
    return g * a + (1 - g) * b
```

```asm
; @launch grid=(256,1,1) block=(384,1,1) lds=124416
.amdgcn_target "amdgcn-amd-amdhsa--gfx950"
.text
.globl gated_mix__mha_block_cached__glu_gated_swiglu__decode_kernel
.p2align 8
.type gated_mix__mha_block_cached__glu_gated_swiglu__decode_kernel,@function
gated_mix__mha_block_cached__glu_gated_swiglu__decode_kernel:
  s_cmp_ge_u32 s2, 256
  s_cbranch_scc1 L_end
  s_load_dwordx16 s[16:31], s[0:1], 0
  s_load_dwordx8 s[32:39], s[0:1], 64
  s_load_dwordx2 s[40:41], s[0:1], 96
  v_lshrrev_b32 v1, 6, v0
  v_and_b32 v0, 63, v0
  v_readfirstlane_b32 s3, v1
  s_lshr_b32 s4, s2, 3
  s_and_b32 s5, s2, 7
  s_lshr_b32 s73, s4, 4
  s_lshl_b32 s6, s5, 1
  s_add_u32 s6, s6, s73
  s_and_b32 s8, s4, 15
  s_lshl_b32 s7, s5, 1
  s_add_u32 s7, s7, s4
  s_and_b32 s7, s7, 15
  s_mul_i32 s73, s4, 52
  s_lshr_b32 s73, s73, 8
  s_mul_i32 s74, s73, 5
  s_sub_u32 s101, s4, s74
  s_and_b32 s74, s73, 1
  s_lshr_b32 s73, s73, 1
  s_lshl_b32 s73, s73, 4
  s_add_u32 s73, s73, s74
  s_lshl_b32 s74, s5, 1
  s_add_u32 s73, s73, s74
  s_cmp_lt_u32 s4, 20
  s_cselect_b32 s100, s73, 255
  s_mov_b32 s71, 0x3fb8aa3b
  s_mov_b32 s72, 0x3d93cd3a
  s_mov_b32 s79, 0x05040100
  s_mov_b32 s80, 0x07060302
  s_cmp_eq_u32 s3, 0
  s_cbranch_scc1 L_M
  s_cmp_eq_u32 s3, 5
  s_cbranch_scc1 L_X
  s_sub_u32 s3, s3, 1
  s_mul_i32 s9, s6, 3145728
  s_mul_i32 s73, s8, 24576
  s_add_u32 s9, s9, s73
  s_mov_b32 s68, s9
  s_mov_b32 s13, 1
  s_mul_i32 s75, s3, 3072
  v_lshrrev_b32 v1, 3, v0
  v_mul_u32_u24 v1, 384, v1
  v_and_b32 v13, 7, v0
  v_lshl_add_u32 v1, v13, 4, v1
  v_add_u32 v1, s75, v1
  s_waitcnt lgkmcnt(0)
  s_mov_b32 s44, s18
  s_mov_b32 s45, s19
  s_mov_b32 s46, 402653184
  s_mov_b32 s47, 0x00020000
  s_mov_b32 s48, s20
  s_mov_b32 s49, s21
  s_mov_b32 s50, 402653184
  s_mov_b32 s51, 0x00020000
  s_mov_b32 s52, s40
  s_mov_b32 s53, s41
  s_mov_b32 s54, 2150400
  s_mov_b32 s55, 0x00020000
  buffer_load_dwordx4 v[64:67], v1, s[44:47], s68 offen offset:0 nt
  buffer_load_dwordx4 v[68:71], v1, s[44:47], s68 offen offset:128 nt
  buffer_load_dwordx4 v[72:75], v1, s[44:47], s68 offen offset:256 nt
  s_add_u32 s68, s68, 12288
  buffer_load_dwordx4 v[76:79], v1, s[44:47], s68 offen offset:0 nt
  buffer_load_dwordx4 v[80:83], v1, s[44:47], s68 offen offset:128 nt
  buffer_load_dwordx4 v[84:87], v1, s[44:47], s68 offen offset:256 nt
  s_add_u32 s68, s68, 380928
  v_and_b32 v13, 1, v0
  v_lshlrev_b32 v13, 4, v13
  v_mov_b32 v12, 0xffff
  v_lshlrev_b32 v12, v13, v12
  v_bfe_u32 v13, v0, 1, 2
  v_cmp_eq_u32 vcc, 0, v13
  s_nop 1
  v_cndmask_b32 v2, 0, v12, vcc
  v_cmp_eq_u32 vcc, 1, v13
  s_nop 1
  v_cndmask_b32 v3, 0, v12, vcc
  v_cmp_eq_u32 vcc, 2, v13
  s_nop 1
  v_cndmask_b32 v4, 0, v12, vcc
  v_cmp_eq_u32 vcc, 3, v13
  s_nop 1
  v_cndmask_b32 v5, 0, v12, vcc
  v_mov_b32 v15, 0
  v_and_b32 v16, 7, v0
  v_lshlrev_b32 v16, 4, v16
  v_lshrrev_b32 v18, 4, v0
  v_lshlrev_b32 v18, 2, v18
  s_lshl_b32 s73, s3, 4
  s_add_u32 s73, s73, 4352
  v_add_u32 v18, s73, v18
  s_lshl_b32 s73, s3, 2
  s_add_u32 s73, s73, 4352
  v_mov_b32 v17, s73
  v_lshrrev_b32 v19, 5, v0
  v_mul_u32_u24 v19, 768, v19
  v_lshl_add_u32 v19, v16, 1, v19
  v_and_b32 v13, 16, v0
  v_add_u32 v19, v19, v13
  s_mul_i32 s73, s3, 1536
  s_add_u32 s73, s73, 4352
  v_add_u32 v19, s73, v19
  s_mul_i32 s11, s7, 3145728
  s_add_u32 s11, s11, 352321536
  s_mul_i32 s10, s6, 49152
  s_add_u32 s10, s10, s11
  s_add_u32 s11, s11, 786432
  v_lshrrev_b32 v0, 3, v0
  v_mul_u32_u24 v0, 80, v0
  s_mul_i32 s73, s3, 5120
  s_add_u32 s73, s73, 54784
  v_add_u32 v0, s73, v0
  s_waitcnt vmcnt(3)
  buffer_load_dwordx4 v[88:91], v1, s[44:47], s68 offen offset:0 nt
  buffer_load_dwordx4 v[92:95], v1, s[44:47], s68 offen offset:128 nt
  buffer_load_dwordx4 v[96:99], v1, s[44:47], s68 offen offset:256 nt
  s_add_u32 s68, s68, 12288
  s_waitcnt vmcnt(3)
  buffer_load_dwordx4 v[100:103], v1, s[44:47], s68 offen offset:0 nt
  buffer_load_dwordx4 v[104:107], v1, s[44:47], s68 offen offset:128 nt
  buffer_load_dwordx4 v[108:111], v1, s[44:47], s68 offen offset:256 nt
  s_add_u32 s68, s68, 380928
  s_waitcnt vmcnt(3)
  buffer_load_dwordx4 v[112:115], v1, s[44:47], s68 offen offset:0 nt
  buffer_load_dwordx4 v[116:119], v1, s[44:47], s68 offen offset:128 nt
  buffer_load_dwordx4 v[120:123], v1, s[44:47], s68 offen offset:256 nt
  s_add_u32 s68, s68, 12288
  s_waitcnt vmcnt(3)
  buffer_load_dwordx4 v[124:127], v1, s[44:47], s68 offen offset:0 nt
  buffer_load_dwordx4 v[128:131], v1, s[44:47], s68 offen offset:128 nt
  buffer_load_dwordx4 v[132:135], v1, s[44:47], s68 offen offset:256 nt
  s_add_u32 s68, s68, 380928
  s_waitcnt vmcnt(3)
  buffer_load_dwordx4 v[136:139], v1, s[44:47], s68 offen offset:0 nt
  buffer_load_dwordx4 v[140:143], v1, s[44:47], s68 offen offset:128 nt
  buffer_load_dwordx4 v[144:147], v1, s[44:47], s68 offen offset:256 nt
  s_add_u32 s68, s68, 12288
  s_waitcnt vmcnt(3)
  buffer_load_dwordx4 v[148:151], v1, s[44:47], s68 offen offset:0 nt
  buffer_load_dwordx4 v[152:155], v1, s[44:47], s68 offen offset:128 nt
  buffer_load_dwordx4 v[156:159], v1, s[44:47], s68 offen offset:256 nt
  s_add_u32 s68, s68, 380928
  s_waitcnt vmcnt(3)
  buffer_load_dwordx4 v[160:163], v1, s[44:47], s68 offen offset:0 nt
  buffer_load_dwordx4 v[164:167], v1, s[44:47], s68 offen offset:128 nt
  buffer_load_dwordx4 v[168:171], v1, s[44:47], s68 offen offset:256 nt
  s_add_u32 s68, s68, 12288
  s_waitcnt vmcnt(3)
  buffer_load_dwordx4 v[172:175], v1, s[44:47], s68 offen offset:0 nt
  buffer_load_dwordx4 v[176:179], v1, s[44:47], s68 offen offset:128 nt
  buffer_load_dwordx4 v[180:183], v1, s[44:47], s68 offen offset:256 nt
  s_add_u32 s68, s68, 380928
  s_waitcnt vmcnt(3)
  buffer_load_dwordx4 v[184:187], v1, s[44:47], s68 offen offset:0 nt
  buffer_load_dwordx4 v[188:191], v1, s[44:47], s68 offen offset:128 nt
  buffer_load_dwordx4 v[192:195], v1, s[44:47], s68 offen offset:256 nt
  s_add_u32 s68, s68, 12288
  s_waitcnt vmcnt(3)
  buffer_load_dwordx4 v[196:199], v1, s[44:47], s68 offen offset:0 nt
  buffer_load_dwordx4 v[200:203], v1, s[44:47], s68 offen offset:128 nt
  buffer_load_dwordx4 v[204:207], v1, s[44:47], s68 offen offset:256 nt
  s_add_u32 s68, s68, 380928
  s_waitcnt vmcnt(3)
  buffer_load_dwordx4 v[208:211], v1, s[44:47], s68 offen offset:0 nt
  buffer_load_dwordx4 v[212:215], v1, s[44:47], s68 offen offset:128 nt
  buffer_load_dwordx4 v[216:219], v1, s[44:47], s68 offen offset:256 nt
  s_add_u32 s68, s68, 12288
  s_waitcnt vmcnt(3)
  buffer_load_dwordx4 v[220:223], v1, s[44:47], s68 offen offset:0 nt
  buffer_load_dwordx4 v[224:227], v1, s[44:47], s68 offen offset:128 nt
  buffer_load_dwordx4 v[228:231], v1, s[44:47], s68 offen offset:256 nt
  s_add_u32 s68, s68, 380928
  s_waitcnt vmcnt(3)
  buffer_load_dwordx4 v[232:235], v1, s[44:47], s68 offen offset:0 nt
  buffer_load_dwordx4 v[236:239], v1, s[44:47], s68 offen offset:128 nt
  buffer_load_dwordx4 v[240:243], v1, s[44:47], s68 offen offset:256 nt
  s_add_u32 s68, s68, 12288
  s_waitcnt vmcnt(3)
  buffer_load_dwordx4 v[244:247], v1, s[44:47], s68 offen offset:0 nt
  buffer_load_dwordx4 v[248:251], v1, s[44:47], s68 offen offset:128 nt
  buffer_load_dwordx4 v[252:255], v1, s[44:47], s68 offen offset:256 nt
  s_add_u32 s68, s68, 47566848
  s_barrier
  ds_read_b128 v[24:27], v16 offset:128
  ds_read_b128 v[28:31], v16 offset:256
  ds_read_b128 v[32:35], v16 offset:384
  s_waitcnt lgkmcnt(0)
  v_dot2_f32_bf16 v9, v64, v24, 0
  v_dot2_f32_bf16 v10, v68, v28, 0
  v_dot2_f32_bf16 v11, v72, v32, 0
  v_dot2_f32_bf16 v9, v65, v25, v9
  v_dot2_f32_bf16 v10, v69, v29, v10
  v_dot2_f32_bf16 v11, v73, v33, v11
  v_dot2_f32_bf16 v9, v66, v26, v9
  v_dot2_f32_bf16 v10, v70, v30, v10
  v_dot2_f32_bf16 v11, v74, v34, v11
  v_dot2_f32_bf16 v9, v67, v27, v9
  v_dot2_f32_bf16 v10, v71, v31, v10
  v_dot2_f32_bf16 v11, v75, v35, v11
  s_nop 1
  v_add_f32 v12, v9, v10
  v_add_f32 v12, v12, v11
  s_nop 1
  v_add_f32_dpp v12, v12, v12 quad_perm:[1,0,3,2] row_mask:0xf bank_mask:0xf
  s_nop 1
  v_add_f32_dpp v12, v12, v12 quad_perm:[2,3,0,1] row_mask:0xf bank_mask:0xf
  s_nop 1
  v_add_f32_dpp v12, v12, v12 row_half_mirror row_mask:0xf bank_mask:0xf
  v_cvt_pk_bf16_f32 v12, v12, v12
  v_lshlrev_b32 v12, 16, v12
  v_mul_f32 v12, s72, v12
  v_cvt_pk_bf16_f32 v12, v12, v12
  v_lshlrev_b32 v48, 16, v12
  v_mov_b32 v6, v48
  buffer_load_dwordx4 v[64:67], v1, s[44:47], s68 offen offset:0 nt
  buffer_load_dwordx4 v[68:71], v1, s[44:47], s68 offen offset:128 nt
  buffer_load_dwordx4 v[72:75], v1, s[44:47], s68 offen offset:256 nt
  s_add_u32 s68, s68, 12288
  v_dot2_f32_bf16 v9, v76, v24, 0
  v_dot2_f32_bf16 v10, v80, v28, 0
  v_dot2_f32_bf16 v11, v84, v32, 0
  v_dot2_f32_bf16 v9, v77, v25, v9
  v_dot2_f32_bf16 v10, v81, v29, v10
  v_dot2_f32_bf16 v11, v85, v33, v11
  v_dot2_f32_bf16 v9, v78, v26, v9
  v_dot2_f32_bf16 v10, v82, v30, v10
  v_dot2_f32_bf16 v11, v86, v34, v11
  v_dot2_f32_bf16 v9, v79, v27, v9
  v_dot2_f32_bf16 v10, v83, v31, v10
  v_dot2_f32_bf16 v11, v87, v35, v11
  s_nop 1
  v_add_f32 v12, v9, v10
  v_add_f32 v12, v12, v11
  s_nop 1
  v_add_f32_dpp v12, v12, v12 quad_perm:[1,0,3,2] row_mask:0xf bank_mask:0xf
  s_nop 1
  v_add_f32_dpp v12, v12, v12 quad_perm:[2,3,0,1] row_mask:0xf bank_mask:0xf
  s_nop 1
  v_add_f32_dpp v12, v12, v12 row_half_mirror row_mask:0xf bank_mask:0xf
  v_cvt_pk_bf16_f32 v12, v12, v12
  v_lshlrev_b32 v12, 16, v12
  v_mul_f32 v12, s72, v12
  v_cvt_pk_bf16_f32 v12, v12, v12
  v_lshlrev_b32 v49, 16, v12
  v_max_f32 v6, v6, v49
  buffer_load_dwordx4 v[76:79], v1, s[44:47], s68 offen offset:0 nt
  buffer_load_dwordx4 v[80:83], v1, s[44:47], s68 offen offset:128 nt
  buffer_load_dwordx4 v[84:87], v1, s[44:47], s68 offen offset:256 nt
  s_add_u32 s68, s68, 380928
  v_dot2_f32_bf16 v9, v88, v24, 0
  v_dot2_f32_bf16 v10, v92, v28, 0
  v_dot2_f32_bf16 v11, v96, v32, 0
  v_dot2_f32_bf16 v9, v89, v25, v9
  v_dot2_f32_bf16 v10, v93, v29, v10
  v_dot2_f32_bf16 v11, v97, v33, v11
  v_dot2_f32_bf16 v9, v90, v26, v9
  v_dot2_f32_bf16 v10, v94, v30, v10
  v_dot2_f32_bf16 v11, v98, v34, v11
  v_dot2_f32_bf16 v9, v91, v27, v9
  v_dot2_f32_bf16 v10, v95, v31, v10
  v_dot2_f32_bf16 v11, v99, v35, v11
  s_nop 1
  v_add_f32 v12, v9, v10
  v_add_f32 v12, v12, v11
  s_nop 1
  v_add_f32_dpp v12, v12, v12 quad_perm:[1,0,3,2] row_mask:0xf bank_mask:0xf
  s_nop 1
  v_add_f32_dpp v12, v12, v12 quad_perm:[2,3,0,1] row_mask:0xf bank_mask:0xf
  s_nop 1
  v_add_f32_dpp v12, v12, v12 row_half_mirror row_mask:0xf bank_mask:0xf
  v_cvt_pk_bf16_f32 v12, v12, v12
  v_lshlrev_b32 v12, 16, v12
  v_mul_f32 v12, s72, v12
  v_cvt_pk_bf16_f32 v12, v12, v12
  v_lshlrev_b32 v50, 16, v12
  v_max_f32 v6, v6, v50
  v_dot2_f32_bf16 v9, v100, v24, 0
  v_dot2_f32_bf16 v10, v104, v28, 0
  v_dot2_f32_bf16 v11, v108, v32, 0
  v_dot2_f32_bf16 v9, v101, v25, v9
  v_dot2_f32_bf16 v10, v105, v29, v10
  v_dot2_f32_bf16 v11, v109, v33, v11
  v_dot2_f32_bf16 v9, v102, v26, v9
  v_dot2_f32_bf16 v10, v106, v30, v10
  v_dot2_f32_bf16 v11, v110, v34, v11
  v_dot2_f32_bf16 v9, v103, v27, v9
  v_dot2_f32_bf16 v10, v107, v31, v10
  v_dot2_f32_bf16 v11, v111, v35, v11
  s_nop 1
  v_add_f32 v12, v9, v10
  v_add_f32 v12, v12, v11
  s_nop 1
  v_add_f32_dpp v12, v12, v12 quad_perm:[1,0,3,2] row_mask:0xf bank_mask:0xf
  s_nop 1
  v_add_f32_dpp v12, v12, v12 quad_perm:[2,3,0,1] row_mask:0xf bank_mask:0xf
  s_nop 1
  v_add_f32_dpp v12, v12, v12 row_half_mirror row_mask:0xf bank_mask:0xf
  v_cvt_pk_bf16_f32 v12, v12, v12
  v_lshlrev_b32 v12, 16, v12
  v_mul_f32 v12, s72, v12
  v_cvt_pk_bf16_f32 v12, v12, v12
  v_lshlrev_b32 v51, 16, v12
  v_max_f32 v6, v6, v51
  v_dot2_f32_bf16 v9, v112, v24, 0
  v_dot2_f32_bf16 v10, v116, v28, 0
  v_dot2_f32_bf16 v11, v120, v32, 0
  v_dot2_f32_bf16 v9, v113, v25, v9
  v_dot2_f32_bf16 v10, v117, v29, v10
  v_dot2_f32_bf16 v11, v121, v33, v11
  v_dot2_f32_bf16 v9, v114, v26, v9
  v_dot2_f32_bf16 v10, v118, v30, v10
  v_dot2_f32_bf16 v11, v122, v34, v11
  v_dot2_f32_bf16 v9, v115, v27, v9
  v_dot2_f32_bf16 v10, v119, v31, v10
  v_dot2_f32_bf16 v11, v123, v35, v11
  s_nop 1
  v_add_f32 v12, v9, v10
  v_add_f32 v12, v12, v11
  s_nop 1
  v_add_f32_dpp v12, v12, v12 quad_perm:[1,0,3,2] row_mask:0xf bank_mask:0xf
  s_nop 1
  v_add_f32_dpp v12, v12, v12 quad_perm:[2,3,0,1] row_mask:0xf bank_mask:0xf
  s_nop 1
  v_add_f32_dpp v12, v12, v12 row_half_mirror row_mask:0xf bank_mask:0xf
  v_cvt_pk_bf16_f32 v12, v12, v12
  v_lshlrev_b32 v12, 16, v12
  v_mul_f32 v12, s72, v12
  v_cvt_pk_bf16_f32 v12, v12, v12
  v_lshlrev_b32 v52, 16, v12
  v_max_f32 v6, v6, v52
  v_dot2_f32_bf16 v9, v124, v24, 0
  v_dot2_f32_bf16 v10, v128, v28, 0
  v_dot2_f32_bf16 v11, v132, v32, 0
  v_dot2_f32_bf16 v9, v125, v25, v9
  v_dot2_f32_bf16 v10, v129, v29, v10
  v_dot2_f32_bf16 v11, v133, v33, v11
  v_dot2_f32_bf16 v9, v126, v26, v9
  v_dot2_f32_bf16 v10, v130, v30, v10
  v_dot2_f32_bf16 v11, v134, v34, v11
  v_dot2_f32_bf16 v9, v127, v27, v9
  v_dot2_f32_bf16 v10, v131, v31, v10
  v_dot2_f32_bf16 v11, v135, v35, v11
  s_nop 1
  v_add_f32 v12, v9, v10
  v_add_f32 v12, v12, v11
  s_nop 1
  v_add_f32_dpp v12, v12, v12 quad_perm:[1,0,3,2] row_mask:0xf bank_mask:0xf
  s_nop 1
  v_add_f32_dpp v12, v12, v12 quad_perm:[2,3,0,1] row_mask:0xf bank_mask:0xf
  s_nop 1
  v_add_f32_dpp v12, v12, v12 row_half_mirror row_mask:0xf bank_mask:0xf
  v_cvt_pk_bf16_f32 v12, v12, v12
  v_lshlrev_b32 v12, 16, v12
  v_mul_f32 v12, s72, v12
  v_cvt_pk_bf16_f32 v12, v12, v12
  v_lshlrev_b32 v53, 16, v12
  v_max_f32 v6, v6, v53
  buffer_load_dwordx4 v[88:91], v1, s[44:47], s68 offen offset:0 nt
  buffer_load_dwordx4 v[92:95], v1, s[44:47], s68 offen offset:128 nt
  buffer_load_dwordx4 v[96:99], v1, s[44:47], s68 offen offset:256 nt
  s_add_u32 s68, s68, 12288
  v_dot2_f32_bf16 v9, v136, v24, 0
  v_dot2_f32_bf16 v10, v140, v28, 0
  v_dot2_f32_bf16 v11, v144, v32, 0
  v_dot2_f32_bf16 v9, v137, v25, v9
  v_dot2_f32_bf16 v10, v141, v29, v10
  v_dot2_f32_bf16 v11, v145, v33, v11
  v_dot2_f32_bf16 v9, v138, v26, v9
  v_dot2_f32_bf16 v10, v142, v30, v10
  v_dot2_f32_bf16 v11, v146, v34, v11
  v_dot2_f32_bf16 v9, v139, v27, v9
  v_dot2_f32_bf16 v10, v143, v31, v10
  v_dot2_f32_bf16 v11, v147, v35, v11
  s_nop 1
  v_add_f32 v12, v9, v10
  v_add_f32 v12, v12, v11
  s_nop 1
  v_add_f32_dpp v12, v12, v12 quad_perm:[1,0,3,2] row_mask:0xf bank_mask:0xf
  s_nop 1
  v_add_f32_dpp v12, v12, v12 quad_perm:[2,3,0,1] row_mask:0xf bank_mask:0xf
  s_nop 1
  v_add_f32_dpp v12, v12, v12 row_half_mirror row_mask:0xf bank_mask:0xf
  v_cvt_pk_bf16_f32 v12, v12, v12
  v_lshlrev_b32 v12, 16, v12
  v_mul_f32 v12, s72, v12
  v_cvt_pk_bf16_f32 v12, v12, v12
  v_lshlrev_b32 v54, 16, v12
  v_max_f32 v6, v6, v54
  v_dot2_f32_bf16 v9, v148, v24, 0
  v_dot2_f32_bf16 v10, v152, v28, 0
  v_dot2_f32_bf16 v11, v156, v32, 0
  v_dot2_f32_bf16 v9, v149, v25, v9
  v_dot2_f32_bf16 v10, v153, v29, v10
  v_dot2_f32_bf16 v11, v157, v33, v11
  v_dot2_f32_bf16 v9, v150, v26, v9
  v_dot2_f32_bf16 v10, v154, v30, v10
  v_dot2_f32_bf16 v11, v158, v34, v11
  v_dot2_f32_bf16 v9, v151, v27, v9
  v_dot2_f32_bf16 v10, v155, v31, v10
  v_dot2_f32_bf16 v11, v159, v35, v11
  s_nop 1
  v_add_f32 v12, v9, v10
  v_add_f32 v12, v12, v11
  s_nop 1
  v_add_f32_dpp v12, v12, v12 quad_perm:[1,0,3,2] row_mask:0xf bank_mask:0xf
  s_nop 1
  v_add_f32_dpp v12, v12, v12 quad_perm:[2,3,0,1] row_mask:0xf bank_mask:0xf
  s_nop 1
  v_add_f32_dpp v12, v12, v12 row_half_mirror row_mask:0xf bank_mask:0xf
  v_cvt_pk_bf16_f32 v12, v12, v12
  v_lshlrev_b32 v12, 16, v12
  v_mul_f32 v12, s72, v12
  v_cvt_pk_bf16_f32 v12, v12, v12
  v_lshlrev_b32 v55, 16, v12
  v_max_f32 v6, v6, v55
  v_dot2_f32_bf16 v9, v160, v24, 0
  v_dot2_f32_bf16 v10, v164, v28, 0
  v_dot2_f32_bf16 v11, v168, v32, 0
  v_dot2_f32_bf16 v9, v161, v25, v9
  v_dot2_f32_bf16 v10, v165, v29, v10
  v_dot2_f32_bf16 v11, v169, v33, v11
  v_dot2_f32_bf16 v9, v162, v26, v9
  v_dot2_f32_bf16 v10, v166, v30, v10
  v_dot2_f32_bf16 v11, v170, v34, v11
  v_dot2_f32_bf16 v9, v163, v27, v9
  v_dot2_f32_bf16 v10, v167, v31, v10
  v_dot2_f32_bf16 v11, v171, v35, v11
  s_nop 1
  v_add_f32 v12, v9, v10
  v_add_f32 v12, v12, v11
  s_nop 1
  v_add_f32_dpp v12, v12, v12 quad_perm:[1,0,3,2] row_mask:0xf bank_mask:0xf
  s_nop 1
  v_add_f32_dpp v12, v12, v12 quad_perm:[2,3,0,1] row_mask:0xf bank_mask:0xf
  s_nop 1
  v_add_f32_dpp v12, v12, v12 row_half_mirror row_mask:0xf bank_mask:0xf
  v_cvt_pk_bf16_f32 v12, v12, v12
  v_lshlrev_b32 v12, 16, v12
  v_mul_f32 v12, s72, v12
  v_cvt_pk_bf16_f32 v12, v12, v12
  v_lshlrev_b32 v56, 16, v12
  v_max_f32 v6, v6, v56
  v_dot2_f32_bf16 v9, v172, v24, 0
  v_dot2_f32_bf16 v10, v176, v28, 0
  v_dot2_f32_bf16 v11, v180, v32, 0
  v_dot2_f32_bf16 v9, v173, v25, v9
  v_dot2_f32_bf16 v10, v177, v29, v10
  v_dot2_f32_bf16 v11, v181, v33, v11
  v_dot2_f32_bf16 v9, v174, v26, v9
  v_dot2_f32_bf16 v10, v178, v30, v10
  v_dot2_f32_bf16 v11, v182, v34, v11
  v_dot2_f32_bf16 v9, v175, v27, v9
  v_dot2_f32_bf16 v10, v179, v31, v10
  v_dot2_f32_bf16 v11, v183, v35, v11
  s_nop 1
  v_add_f32 v12, v9, v10
  v_add_f32 v12, v12, v11
  s_nop 1
  v_add_f32_dpp v12, v12, v12 quad_perm:[1,0,3,2] row_mask:0xf bank_mask:0xf
  s_nop 1
  v_add_f32_dpp v12, v12, v12 quad_perm:[2,3,0,1] row_mask:0xf bank_mask:0xf
  s_nop 1
  v_add_f32_dpp v12, v12, v12 row_half_mirror row_mask:0xf bank_mask:0xf
  v_cvt_pk_bf16_f32 v12, v12, v12
  v_lshlrev_b32 v12, 16, v12
  v_mul_f32 v12, s72, v12
  v_cvt_pk_bf16_f32 v12, v12, v12
  v_lshlrev_b32 v57, 16, v12
  v_max_f32 v6, v6, v57
  buffer_load_dwordx4 v[100:103], v1, s[44:47], s68 offen offset:0 nt
  buffer_load_dwordx4 v[104:107], v1, s[44:47], s68 offen offset:128 nt
  buffer_load_dwordx4 v[108:111], v1, s[44:47], s68 offen offset:256 nt
  s_add_u32 s68, s68, 380928
  v_dot2_f32_bf16 v9, v184, v24, 0
  v_dot2_f32_bf16 v10, v188, v28, 0
  v_dot2_f32_bf16 v11, v192, v32, 0
  v_dot2_f32_bf16 v9, v185, v25, v9
  v_dot2_f32_bf16 v10, v189, v29, v10
  v_dot2_f32_bf16 v11, v193, v33, v11
  v_dot2_f32_bf16 v9, v186, v26, v9
  v_dot2_f32_bf16 v10, v190, v30, v10
  v_dot2_f32_bf16 v11, v194, v34, v11
  v_dot2_f32_bf16 v9, v187, v27, v9
  v_dot2_f32_bf16 v10, v191, v31, v10
  v_dot2_f32_bf16 v11, v195, v35, v11
  s_nop 1
  v_add_f32 v12, v9, v10
  v_add_f32 v12, v12, v11
  s_nop 1
  v_add_f32_dpp v12, v12, v12 quad_perm:[1,0,3,2] row_mask:0xf bank_mask:0xf
  s_nop 1
  v_add_f32_dpp v12, v12, v12 quad_perm:[2,3,0,1] row_mask:0xf bank_mask:0xf
  s_nop 1
  v_add_f32_dpp v12, v12, v12 row_half_mirror row_mask:0xf bank_mask:0xf
  v_cvt_pk_bf16_f32 v12, v12, v12
  v_lshlrev_b32 v12, 16, v12
  v_mul_f32 v12, s72, v12
  v_cvt_pk_bf16_f32 v12, v12, v12
  v_lshlrev_b32 v58, 16, v12
  v_max_f32 v6, v6, v58
  v_dot2_f32_bf16 v9, v196, v24, 0
  v_dot2_f32_bf16 v10, v200, v28, 0
  v_dot2_f32_bf16 v11, v204, v32, 0
  v_dot2_f32_bf16 v9, v197, v25, v9
  v_dot2_f32_bf16 v10, v201, v29, v10
  v_dot2_f32_bf16 v11, v205, v33, v11
  v_dot2_f32_bf16 v9, v198, v26, v9
  v_dot2_f32_bf16 v10, v202, v30, v10
  v_dot2_f32_bf16 v11, v206, v34, v11
  v_dot2_f32_bf16 v9, v199, v27, v9
  v_dot2_f32_bf16 v10, v203, v31, v10
  v_dot2_f32_bf16 v11, v207, v35, v11
  s_nop 1
  v_add_f32 v12, v9, v10
  v_add_f32 v12, v12, v11
  s_nop 1
  v_add_f32_dpp v12, v12, v12 quad_perm:[1,0,3,2] row_mask:0xf bank_mask:0xf
  s_nop 1
  v_add_f32_dpp v12, v12, v12 quad_perm:[2,3,0,1] row_mask:0xf bank_mask:0xf
  s_nop 1
  v_add_f32_dpp v12, v12, v12 row_half_mirror row_mask:0xf bank_mask:0xf
  v_cvt_pk_bf16_f32 v12, v12, v12
  v_lshlrev_b32 v12, 16, v12
  v_mul_f32 v12, s72, v12
  v_cvt_pk_bf16_f32 v12, v12, v12
  v_lshlrev_b32 v59, 16, v12
  v_max_f32 v6, v6, v59
  v_dot2_f32_bf16 v9, v208, v24, 0
  v_dot2_f32_bf16 v10, v212, v28, 0
  v_dot2_f32_bf16 v11, v216, v32, 0
  v_dot2_f32_bf16 v9, v209, v25, v9
  v_dot2_f32_bf16 v10, v213, v29, v10
  v_dot2_f32_bf16 v11, v217, v33, v11
  v_dot2_f32_bf16 v9, v210, v26, v9
  v_dot2_f32_bf16 v10, v214, v30, v10
  v_dot2_f32_bf16 v11, v218, v34, v11
  v_dot2_f32_bf16 v9, v211, v27, v9
  v_dot2_f32_bf16 v10, v215, v31, v10
  v_dot2_f32_bf16 v11, v219, v35, v11
  s_nop 1
  v_add_f32 v12, v9, v10
  v_add_f32 v12, v12, v11
  s_nop 1
  v_add_f32_dpp v12, v12, v12 quad_perm:[1,0,3,2] row_mask:0xf bank_mask:0xf
  s_nop 1
  v_add_f32_dpp v12, v12, v12 quad_perm:[2,3,0,1] row_mask:0xf bank_mask:0xf
  s_nop 1
  v_add_f32_dpp v12, v12, v12 row_half_mirror row_mask:0xf bank_mask:0xf
  v_cvt_pk_bf16_f32 v12, v12, v12
  v_lshlrev_b32 v12, 16, v12
  v_mul_f32 v12, s72, v12
  v_cvt_pk_bf16_f32 v12, v12, v12
  v_lshlrev_b32 v60, 16, v12
  v_max_f32 v6, v6, v60
  v_dot2_f32_bf16 v9, v220, v24, 0
  v_dot2_f32_bf16 v10, v224, v28, 0
  v_dot2_f32_bf16 v11, v228, v32, 0
  v_dot2_f32_bf16 v9, v221, v25, v9
  v_dot2_f32_bf16 v10, v225, v29, v10
  v_dot2_f32_bf16 v11, v229, v33, v11
  v_dot2_f32_bf16 v9, v222, v26, v9
  v_dot2_f32_bf16 v10, v226, v30, v10
  v_dot2_f32_bf16 v11, v230, v34, v11
  v_dot2_f32_bf16 v9, v223, v27, v9
  v_dot2_f32_bf16 v10, v227, v31, v10
  v_dot2_f32_bf16 v11, v231, v35, v11
  s_nop 1
  v_add_f32 v12, v9, v10
  v_add_f32 v12, v12, v11
  s_nop 1
  v_add_f32_dpp v12, v12, v12 quad_perm:[1,0,3,2] row_mask:0xf bank_mask:0xf
  s_nop 1
  v_add_f32_dpp v12, v12, v12 quad_perm:[2,3,0,1] row_mask:0xf bank_mask:0xf
  s_nop 1
  v_add_f32_dpp v12, v12, v12 row_half_mirror row_mask:0xf bank_mask:0xf
  v_cvt_pk_bf16_f32 v12, v12, v12
  v_lshlrev_b32 v12, 16, v12
  v_mul_f32 v12, s72, v12
  v_cvt_pk_bf16_f32 v12, v12, v12
  v_lshlrev_b32 v61, 16, v12
  v_max_f32 v6, v6, v61
  s_waitcnt vmcnt(15)
  v_dot2_f32_bf16 v9, v232, v24, 0
  v_dot2_f32_bf16 v10, v236, v28, 0
  v_dot2_f32_bf16 v11, v240, v32, 0
  v_dot2_f32_bf16 v9, v233, v25, v9
  v_dot2_f32_bf16 v10, v237, v29, v10
  v_dot2_f32_bf16 v11, v241, v33, v11
  v_dot2_f32_bf16 v9, v234, v26, v9
  v_dot2_f32_bf16 v10, v238, v30, v10
  v_dot2_f32_bf16 v11, v242, v34, v11
  v_dot2_f32_bf16 v9, v235, v27, v9
  v_dot2_f32_bf16 v10, v239, v31, v10
  v_dot2_f32_bf16 v11, v243, v35, v11
  s_nop 1
  v_add_f32 v12, v9, v10
  v_add_f32 v12, v12, v11
  s_nop 1
  v_add_f32_dpp v12, v12, v12 quad_perm:[1,0,3,2] row_mask:0xf bank_mask:0xf
  s_nop 1
  v_add_f32_dpp v12, v12, v12 quad_perm:[2,3,0,1] row_mask:0xf bank_mask:0xf
  s_nop 1
  v_add_f32_dpp v12, v12, v12 row_half_mirror row_mask:0xf bank_mask:0xf
  v_cvt_pk_bf16_f32 v12, v12, v12
  v_lshlrev_b32 v12, 16, v12
  v_mul_f32 v12, s72, v12
  v_cvt_pk_bf16_f32 v12, v12, v12
  v_lshlrev_b32 v62, 16, v12
  v_max_f32 v6, v6, v62
  s_waitcnt vmcnt(12)
  v_dot2_f32_bf16 v9, v244, v24, 0
  v_dot2_f32_bf16 v10, v248, v28, 0
  v_dot2_f32_bf16 v11, v252, v32, 0
  v_dot2_f32_bf16 v9, v245, v25, v9
  v_dot2_f32_bf16 v10, v249, v29, v10
  v_dot2_f32_bf16 v11, v253, v33, v11
  v_dot2_f32_bf16 v9, v246, v26, v9
  v_dot2_f32_bf16 v10, v250, v30, v10
  v_dot2_f32_bf16 v11, v254, v34, v11
  v_dot2_f32_bf16 v9, v247, v27, v9
  v_dot2_f32_bf16 v10, v251, v31, v10
  v_dot2_f32_bf16 v11, v255, v35, v11
  s_nop 1
  v_add_f32 v12, v9, v10
  v_add_f32 v12, v12, v11
  s_nop 1
  v_add_f32_dpp v12, v12, v12 quad_perm:[1,0,3,2] row_mask:0xf bank_mask:0xf
  s_nop 1
  v_add_f32_dpp v12, v12, v12 quad_perm:[2,3,0,1] row_mask:0xf bank_mask:0xf
  s_nop 1
  v_add_f32_dpp v12, v12, v12 row_half_mirror row_mask:0xf bank_mask:0xf
  v_cvt_pk_bf16_f32 v12, v12, v12
  v_lshlrev_b32 v12, 16, v12
  v_mul_f32 v12, s72, v12
  v_cvt_pk_bf16_f32 v12, v12, v12
  v_lshlrev_b32 v63, 16, v12
  v_max_f32 v6, v6, v63
  s_nop 1
  v_max_f32_dpp v6, v6, v6 row_ror:8 row_mask:0xf bank_mask:0xf
  v_mov_b32 v13, v6
  s_nop 1
  v_permlane16_swap_b32 v6, v13
  s_nop 1
  v_max_f32 v6, v6, v13
  v_mov_b32 v13, v6
  s_nop 1
  v_permlane32_swap_b32 v6, v13
  s_nop 1
  v_max_f32 v6, v6, v13
  v_mul_f32 v7, s71, v6
  v_sub_f32 v7, 0, v7
  s_mov_b32 exec_lo, 0x01010101
  s_mov_b32 exec_hi, 0x01010101
  ds_write_b128 v0, v[48:51] offset:0
  ds_write_b128 v0, v[52:55] offset:16
  ds_write_b128 v0, v[56:59] offset:32
  ds_write_b128 v0, v[60:63] offset:48
  ds_write_b32 v0, v7 offset:64
  s_mov_b64 exec, -1
  v_add_u32 v0, 640, v0
  v_add_u32 v16, 384, v16
  s_add_u32 s13, s13, 1
  s_mov_b32 s81, 1048576
L_q_1:
  ds_read_b32 v13, v15 offset:8
  ds_read_b128 v[24:27], v16 offset:128
  ds_read_b128 v[28:31], v16 offset:256
  ds_read_b128 v[32:35], v16 offset:384
  s_sub_u32 s81, s81, 1
  s_cselect_b32 s82, 0, s13
  s_waitcnt lgkmcnt(0)
  v_cmp_gt_u32 vcc, s82, v13
  s_cbranch_vccnz L_q_1
  s_waitcnt vmcnt(9)
  v_dot2_f32_bf16 v9, v64, v24, 0
  v_dot2_f32_bf16 v10, v68, v28, 0
  v_dot2_f32_bf16 v11, v72, v32, 0
  v_dot2_f32_bf16 v9, v65, v25, v9
  v_dot2_f32_bf16 v10, v69, v29, v10
  v_dot2_f32_bf16 v11, v73, v33, v11
  v_dot2_f32_bf16 v9, v66, v26, v9
  v_dot2_f32_bf16 v10, v70, v30, v10
  v_dot2_f32_bf16 v11, v74, v34, v11
  v_dot2_f32_bf16 v9, v67, v27, v9
  v_dot2_f32_bf16 v10, v71, v31, v10
  v_dot2_f32_bf16 v11, v75, v35, v11
  s_nop 1
  v_add_f32 v12, v9, v10
  v_add_f32 v12, v12, v11
  s_nop 1
  v_add_f32_dpp v12, v12, v12 quad_perm:[1,0,3,2] row_mask:0xf bank_mask:0xf
  s_nop 1
  v_add_f32_dpp v12, v12, v12 quad_perm:[2,3,0,1] row_mask:0xf bank_mask:0xf
  s_nop 1
  v_add_f32_dpp v12, v12, v12 row_half_mirror row_mask:0xf bank_mask:0xf
  v_cvt_pk_bf16_f32 v12, v12, v12
  v_lshlrev_b32 v12, 16, v12
  v_mul_f32 v12, s72, v12
  v_cvt_pk_bf16_f32 v12, v12, v12
  v_lshlrev_b32 v48, 16, v12
  v_mov_b32 v6, v48
  s_waitcnt vmcnt(6)
  v_dot2_f32_bf16 v9, v76, v24, 0
  v_dot2_f32_bf16 v10, v80, v28, 0
  v_dot2_f32_bf16 v11, v84, v32, 0
  v_dot2_f32_bf16 v9, v77, v25, v9
  v_dot2_f32_bf16 v10, v81, v29, v10
  v_dot2_f32_bf16 v11, v85, v33, v11
  v_dot2_f32_bf16 v9, v78, v26, v9
  v_dot2_f32_bf16 v10, v82, v30, v10
  v_dot2_f32_bf16 v11, v86, v34, v11
  v_dot2_f32_bf16 v9, v79, v27, v9
  v_dot2_f32_bf16 v10, v83, v31, v10
  v_dot2_f32_bf16 v11, v87, v35, v11
  s_nop 1
  v_add_f32 v12, v9, v10
  v_add_f32 v12, v12, v11
  s_nop 1
  v_add_f32_dpp v12, v12, v12 quad_perm:[1,0,3,2] row_mask:0xf bank_mask:0xf
  s_nop 1
  v_add_f32_dpp v12, v12, v12 quad_perm:[2,3,0,1] row_mask:0xf bank_mask:0xf
  s_nop 1
  v_add_f32_dpp v12, v12, v12 row_half_mirror row_mask:0xf bank_mask:0xf
  v_cvt_pk_bf16_f32 v12, v12, v12
  v_lshlrev_b32 v12, 16, v12
  v_mul_f32 v12, s72, v12
  v_cvt_pk_bf16_f32 v12, v12, v12
  v_lshlrev_b32 v49, 16, v12
  v_max_f32 v6, v6, v49
  s_mov_b32 s69, 5
L_loop1:
  s_waitcnt vmcnt(3)
  buffer_load_dwordx4 v[64:67], v1, s[44:47], s68 offen offset:0 nt
  buffer_load_dwordx4 v[68:71], v1, s[44:47], s68 offen offset:128 nt
  buffer_load_dwordx4 v[72:75], v1, s[44:47], s68 offen offset:256 nt
  s_add_u32 s68, s68, 12288
  v_dot2_f32_bf16 v9, v88, v24, 0
  v_dot2_f32_bf16 v10, v92, v28, 0
  v_dot2_f32_bf16 v11, v96, v32, 0
  v_dot2_f32_bf16 v9, v89, v25, v9
  v_dot2_f32_bf16 v10, v93, v29, v10
  v_dot2_f32_bf16 v11, v97, v33, v11
  v_dot2_f32_bf16 v9, v90, v26, v9
  v_dot2_f32_bf16 v10, v94, v30, v10
  v_dot2_f32_bf16 v11, v98, v34, v11
  v_dot2_f32_bf16 v9, v91, v27, v9
  v_dot2_f32_bf16 v10, v95, v31, v10
  v_dot2_f32_bf16 v11, v99, v35, v11
  s_nop 1
  v_add_f32 v12, v9, v10
  v_add_f32 v12, v12, v11
  s_nop 1
  v_add_f32_dpp v12, v12, v12 quad_perm:[1,0,3,2] row_mask:0xf bank_mask:0xf
  s_nop 1
  v_add_f32_dpp v12, v12, v12 quad_perm:[2,3,0,1] row_mask:0xf bank_mask:0xf
  s_nop 1
  v_add_f32_dpp v12, v12, v12 row_half_mirror row_mask:0xf bank_mask:0xf
  v_cvt_pk_bf16_f32 v12, v12, v12
  v_lshlrev_b32 v12, 16, v12
  v_mul_f32 v12, s72, v12
  v_cvt_pk_bf16_f32 v12, v12, v12
  v_lshlrev_b32 v50, 16, v12
  v_max_f32 v6, v6, v50
  s_waitcnt vmcnt(3)
  buffer_load_dwordx4 v[76:79], v1, s[44:47], s68 offen offset:0 nt
  buffer_load_dwordx4 v[80:83], v1, s[44:47], s68 offen offset:128 nt
  buffer_load_dwordx4 v[84:87], v1, s[44:47], s68 offen offset:256 nt
  s_add_u32 s68, s68, 380928
  v_dot2_f32_bf16 v9, v100, v24, 0
  v_dot2_f32_bf16 v10, v104, v28, 0
  v_dot2_f32_bf16 v11, v108, v32, 0
  v_dot2_f32_bf16 v9, v101, v25, v9
  v_dot2_f32_bf16 v10, v105, v29, v10
  v_dot2_f32_bf16 v11, v109, v33, v11
  v_dot2_f32_bf16 v9, v102, v26, v9
  v_dot2_f32_bf16 v10, v106, v30, v10
  v_dot2_f32_bf16 v11, v110, v34, v11
  v_dot2_f32_bf16 v9, v103, v27, v9
  v_dot2_f32_bf16 v10, v107, v31, v10
  v_dot2_f32_bf16 v11, v111, v35, v11
  s_nop 1
  v_add_f32 v12, v9, v10
  v_add_f32 v12, v12, v11
  s_nop 1
  v_add_f32_dpp v12, v12, v12 quad_perm:[1,0,3,2] row_mask:0xf bank_mask:0xf
  s_nop 1
  v_add_f32_dpp v12, v12, v12 quad_perm:[2,3,0,1] row_mask:0xf bank_mask:0xf
  s_nop 1
  v_add_f32_dpp v12, v12, v12 row_half_mirror row_mask:0xf bank_mask:0xf
  v_cvt_pk_bf16_f32 v12, v12, v12
  v_lshlrev_b32 v12, 16, v12
  v_mul_f32 v12, s72, v12
  v_cvt_pk_bf16_f32 v12, v12, v12
  v_lshlrev_b32 v51, 16, v12
  v_max_f32 v6, v6, v51
  s_waitcnt vmcnt(3)
  buffer_load_dwordx4 v[88:91], v1, s[44:47], s68 offen offset:0 nt
  buffer_load_dwordx4 v[92:95], v1, s[44:47], s68 offen offset:128 nt
  buffer_load_dwordx4 v[96:99], v1, s[44:47], s68 offen offset:256 nt
  s_add_u32 s68, s68, 12288
  v_dot2_f32_bf16 v9, v64, v24, 0
  v_dot2_f32_bf16 v10, v68, v28, 0
  v_dot2_f32_bf16 v11, v72, v32, 0
  v_dot2_f32_bf16 v9, v65, v25, v9
  v_dot2_f32_bf16 v10, v69, v29, v10
  v_dot2_f32_bf16 v11, v73, v33, v11
  v_dot2_f32_bf16 v9, v66, v26, v9
  v_dot2_f32_bf16 v10, v70, v30, v10
  v_dot2_f32_bf16 v11, v74, v34, v11
  v_dot2_f32_bf16 v9, v67, v27, v9
  v_dot2_f32_bf16 v10, v71, v31, v10
  v_dot2_f32_bf16 v11, v75, v35, v11
  s_nop 1
  v_add_f32 v12, v9, v10
  v_add_f32 v12, v12, v11
  s_nop 1
  v_add_f32_dpp v12, v12, v12 quad_perm:[1,0,3,2] row_mask:0xf bank_mask:0xf
  s_nop 1
  v_add_f32_dpp v12, v12, v12 quad_perm:[2,3,0,1] row_mask:0xf bank_mask:0xf
  s_nop 1
  v_add_f32_dpp v12, v12, v12 row_half_mirror row_mask:0xf bank_mask:0xf
  v_cvt_pk_bf16_f32 v12, v12, v12
  v_lshlrev_b32 v12, 16, v12
  v_mul_f32 v12, s72, v12
  v_cvt_pk_bf16_f32 v12, v12, v12
  v_lshlrev_b32 v52, 16, v12
  v_max_f32 v6, v6, v52
  s_waitcnt vmcnt(3)
  buffer_load_dwordx4 v[100:103], v1, s[44:47], s68 offen offset:0 nt
  buffer_load_dwordx4 v[104:107], v1, s[44:47], s68 offen offset:128 nt
  buffer_load_dwordx4 v[108:111], v1, s[44:47], s68 offen offset:256 nt
  s_add_u32 s68, s68, 380928
  v_dot2_f32_bf16 v9, v76, v24, 0
  v_dot2_f32_bf16 v10, v80, v28, 0
  v_dot2_f32_bf16 v11, v84, v32, 0
  v_dot2_f32_bf16 v9, v77, v25, v9
  v_dot2_f32_bf16 v10, v81, v29, v10
  v_dot2_f32_bf16 v11, v85, v33, v11
  v_dot2_f32_bf16 v9, v78, v26, v9
  v_dot2_f32_bf16 v10, v82, v30, v10
  v_dot2_f32_bf16 v11, v86, v34, v11
  v_dot2_f32_bf16 v9, v79, v27, v9
  v_dot2_f32_bf16 v10, v83, v31, v10
  v_dot2_f32_bf16 v11, v87, v35, v11
  s_nop 1
  v_add_f32 v12, v9, v10
  v_add_f32 v12, v12, v11
  s_nop 1
  v_add_f32_dpp v12, v12, v12 quad_perm:[1,0,3,2] row_mask:0xf bank_mask:0xf
  s_nop 1
  v_add_f32_dpp v12, v12, v12 quad_perm:[2,3,0,1] row_mask:0xf bank_mask:0xf
  s_nop 1
  v_add_f32_dpp v12, v12, v12 row_half_mirror row_mask:0xf bank_mask:0xf
  v_cvt_pk_bf16_f32 v12, v12, v12
  v_lshlrev_b32 v12, 16, v12
  v_mul_f32 v12, s72, v12
  v_cvt_pk_bf16_f32 v12, v12, v12
  v_lshlrev_b32 v53, 16, v12
  v_max_f32 v6, v6, v53
  s_waitcnt vmcnt(3)
  buffer_load_dwordx4 v[64:67], v1, s[44:47], s68 offen offset:0 nt
  buffer_load_dwordx4 v[68:71], v1, s[44:47], s68 offen offset:128 nt
  buffer_load_dwordx4 v[72:75], v1, s[44:47], s68 offen offset:256 nt
  s_add_u32 s68, s68, 12288
  v_dot2_f32_bf16 v9, v88, v24, 0
  v_dot2_f32_bf16 v10, v92, v28, 0
  v_dot2_f32_bf16 v11, v96, v32, 0
  v_dot2_f32_bf16 v9, v89, v25, v9
  v_dot2_f32_bf16 v10, v93, v29, v10
  v_dot2_f32_bf16 v11, v97, v33, v11
  v_dot2_f32_bf16 v9, v90, v26, v9
  v_dot2_f32_bf16 v10, v94, v30, v10
  v_dot2_f32_bf16 v11, v98, v34, v11
  v_dot2_f32_bf16 v9, v91, v27, v9
  v_dot2_f32_bf16 v10, v95, v31, v10
  v_dot2_f32_bf16 v11, v99, v35, v11
  s_nop 1
  v_add_f32 v12, v9, v10
  v_add_f32 v12, v12, v11
  s_nop 1
  v_add_f32_dpp v12, v12, v12 quad_perm:[1,0,3,2] row_mask:0xf bank_mask:0xf
  s_nop 1
  v_add_f32_dpp v12, v12, v12 quad_perm:[2,3,0,1] row_mask:0xf bank_mask:0xf
  s_nop 1
  v_add_f32_dpp v12, v12, v12 row_half_mirror row_mask:0xf bank_mask:0xf
  v_cvt_pk_bf16_f32 v12, v12, v12
  v_lshlrev_b32 v12, 16, v12
  v_mul_f32 v12, s72, v12
  v_cvt_pk_bf16_f32 v12, v12, v12
  v_lshlrev_b32 v54, 16, v12
  v_max_f32 v6, v6, v54
  s_waitcnt vmcnt(3)
  buffer_load_dwordx4 v[76:79], v1, s[44:47], s68 offen offset:0 nt
  buffer_load_dwordx4 v[80:83], v1, s[44:47], s68 offen offset:128 nt
  buffer_load_dwordx4 v[84:87], v1, s[44:47], s68 offen offset:256 nt
  s_add_u32 s68, s68, 380928
  v_dot2_f32_bf16 v9, v100, v24, 0
  v_dot2_f32_bf16 v10, v104, v28, 0
  v_dot2_f32_bf16 v11, v108, v32, 0
  v_dot2_f32_bf16 v9, v101, v25, v9
  v_dot2_f32_bf16 v10, v105, v29, v10
  v_dot2_f32_bf16 v11, v109, v33, v11
  v_dot2_f32_bf16 v9, v102, v26, v9
  v_dot2_f32_bf16 v10, v106, v30, v10
  v_dot2_f32_bf16 v11, v110, v34, v11
  v_dot2_f32_bf16 v9, v103, v27, v9
  v_dot2_f32_bf16 v10, v107, v31, v10
  v_dot2_f32_bf16 v11, v111, v35, v11
  s_nop 1
  v_add_f32 v12, v9, v10
  v_add_f32 v12, v12, v11
  s_nop 1
  v_add_f32_dpp v12, v12, v12 quad_perm:[1,0,3,2] row_mask:0xf bank_mask:0xf
  s_nop 1
  v_add_f32_dpp v12, v12, v12 quad_perm:[2,3,0,1] row_mask:0xf bank_mask:0xf
  s_nop 1
  v_add_f32_dpp v12, v12, v12 row_half_mirror row_mask:0xf bank_mask:0xf
  v_cvt_pk_bf16_f32 v12, v12, v12
  v_lshlrev_b32 v12, 16, v12
  v_mul_f32 v12, s72, v12
  v_cvt_pk_bf16_f32 v12, v12, v12
  v_lshlrev_b32 v55, 16, v12
  v_max_f32 v6, v6, v55
  s_waitcnt vmcnt(3)
  buffer_load_dwordx4 v[88:91], v1, s[44:47], s68 offen offset:0 nt
  buffer_load_dwordx4 v[92:95], v1, s[44:47], s68 offen offset:128 nt
  buffer_load_dwordx4 v[96:99], v1, s[44:47], s68 offen offset:256 nt
  s_add_u32 s68, s68, 12288
  v_dot2_f32_bf16 v9, v64, v24, 0
  v_dot2_f32_bf16 v10, v68, v28, 0
  v_dot2_f32_bf16 v11, v72, v32, 0
  v_dot2_f32_bf16 v9, v65, v25, v9
  v_dot2_f32_bf16 v10, v69, v29, v10
  v_dot2_f32_bf16 v11, v73, v33, v11
  v_dot2_f32_bf16 v9, v66, v26, v9
  v_dot2_f32_bf16 v10, v70, v30, v10
  v_dot2_f32_bf16 v11, v74, v34, v11
  v_dot2_f32_bf16 v9, v67, v27, v9
  v_dot2_f32_bf16 v10, v71, v31, v10
  v_dot2_f32_bf16 v11, v75, v35, v11
  s_nop 1
  v_add_f32 v12, v9, v10
  v_add_f32 v12, v12, v11
  s_nop 1
  v_add_f32_dpp v12, v12, v12 quad_perm:[1,0,3,2] row_mask:0xf bank_mask:0xf
  s_nop 1
  v_add_f32_dpp v12, v12, v12 quad_perm:[2,3,0,1] row_mask:0xf bank_mask:0xf
  s_nop 1
  v_add_f32_dpp v12, v12, v12 row_half_mirror row_mask:0xf bank_mask:0xf
  v_cvt_pk_bf16_f32 v12, v12, v12
  v_lshlrev_b32 v12, 16, v12
  v_mul_f32 v12, s72, v12
  v_cvt_pk_bf16_f32 v12, v12, v12
  v_lshlrev_b32 v56, 16, v12
  v_max_f32 v6, v6, v56
  s_waitcnt vmcnt(3)
  buffer_load_dwordx4 v[100:103], v1, s[44:47], s68 offen offset:0 nt
  buffer_load_dwordx4 v[104:107], v1, s[44:47], s68 offen offset:128 nt
  buffer_load_dwordx4 v[108:111], v1, s[44:47], s68 offen offset:256 nt
  s_add_u32 s68, s68, 380928
  v_dot2_f32_bf16 v9, v76, v24, 0
  v_dot2_f32_bf16 v10, v80, v28, 0
  v_dot2_f32_bf16 v11, v84, v32, 0
  v_dot2_f32_bf16 v9, v77, v25, v9
  v_dot2_f32_bf16 v10, v81, v29, v10
  v_dot2_f32_bf16 v11, v85, v33, v11
  v_dot2_f32_bf16 v9, v78, v26, v9
  v_dot2_f32_bf16 v10, v82, v30, v10
  v_dot2_f32_bf16 v11, v86, v34, v11
  v_dot2_f32_bf16 v9, v79, v27, v9
  v_dot2_f32_bf16 v10, v83, v31, v10
  v_dot2_f32_bf16 v11, v87, v35, v11
  s_nop 1
  v_add_f32 v12, v9, v10
  v_add_f32 v12, v12, v11
  s_nop 1
  v_add_f32_dpp v12, v12, v12 quad_perm:[1,0,3,2] row_mask:0xf bank_mask:0xf
  s_nop 1
  v_add_f32_dpp v12, v12, v12 quad_perm:[2,3,0,1] row_mask:0xf bank_mask:0xf
  s_nop 1
  v_add_f32_dpp v12, v12, v12 row_half_mirror row_mask:0xf bank_mask:0xf
  v_cvt_pk_bf16_f32 v12, v12, v12
  v_lshlrev_b32 v12, 16, v12
  v_mul_f32 v12, s72, v12
  v_cvt_pk_bf16_f32 v12, v12, v12
  v_lshlrev_b32 v57, 16, v12
  v_max_f32 v6, v6, v57
  s_waitcnt vmcnt(3)
  buffer_load_dwordx4 v[64:67], v1, s[44:47], s68 offen offset:0 nt
  buffer_load_dwordx4 v[68:71], v1, s[44:47], s68 offen offset:128 nt
  buffer_load_dwordx4 v[72:75], v1, s[44:47], s68 offen offset:256 nt
  s_add_u32 s68, s68, 12288
  v_dot2_f32_bf16 v9, v88, v24, 0
  v_dot2_f32_bf16 v10, v92, v28, 0
  v_dot2_f32_bf16 v11, v96, v32, 0
  v_dot2_f32_bf16 v9, v89, v25, v9
  v_dot2_f32_bf16 v10, v93, v29, v10
  v_dot2_f32_bf16 v11, v97, v33, v11
  v_dot2_f32_bf16 v9, v90, v26, v9
  v_dot2_f32_bf16 v10, v94, v30, v10
  v_dot2_f32_bf16 v11, v98, v34, v11
  v_dot2_f32_bf16 v9, v91, v27, v9
  v_dot2_f32_bf16 v10, v95, v31, v10
  v_dot2_f32_bf16 v11, v99, v35, v11
  s_nop 1
  v_add_f32 v12, v9, v10
  v_add_f32 v12, v12, v11
  s_nop 1
  v_add_f32_dpp v12, v12, v12 quad_perm:[1,0,3,2] row_mask:0xf bank_mask:0xf
  s_nop 1
  v_add_f32_dpp v12, v12, v12 quad_perm:[2,3,0,1] row_mask:0xf bank_mask:0xf
  s_nop 1
  v_add_f32_dpp v12, v12, v12 row_half_mirror row_mask:0xf bank_mask:0xf
  v_cvt_pk_bf16_f32 v12, v12, v12
  v_lshlrev_b32 v12, 16, v12
  v_mul_f32 v12, s72, v12
  v_cvt_pk_bf16_f32 v12, v12, v12
  v_lshlrev_b32 v58, 16, v12
  v_max_f32 v6, v6, v58
  s_waitcnt vmcnt(3)
  buffer_load_dwordx4 v[76:79], v1, s[44:47], s68 offen offset:0 nt
  buffer_load_dwordx4 v[80:83], v1, s[44:47], s68 offen offset:128 nt
  buffer_load_dwordx4 v[84:87], v1, s[44:47], s68 offen offset:256 nt
  s_add_u32 s68, s68, 380928
  v_dot2_f32_bf16 v9, v100, v24, 0
  v_dot2_f32_bf16 v10, v104, v28, 0
  v_dot2_f32_bf16 v11, v108, v32, 0
  v_dot2_f32_bf16 v9, v101, v25, v9
  v_dot2_f32_bf16 v10, v105, v29, v10
  v_dot2_f32_bf16 v11, v109, v33, v11
  v_dot2_f32_bf16 v9, v102, v26, v9
  v_dot2_f32_bf16 v10, v106, v30, v10
  v_dot2_f32_bf16 v11, v110, v34, v11
  v_dot2_f32_bf16 v9, v103, v27, v9
  v_dot2_f32_bf16 v10, v107, v31, v10
  v_dot2_f32_bf16 v11, v111, v35, v11
  s_nop 1
  v_add_f32 v12, v9, v10
  v_add_f32 v12, v12, v11
  s_nop 1
  v_add_f32_dpp v12, v12, v12 quad_perm:[1,0,3,2] row_mask:0xf bank_mask:0xf
  s_nop 1
  v_add_f32_dpp v12, v12, v12 quad_perm:[2,3,0,1] row_mask:0xf bank_mask:0xf
  s_nop 1
  v_add_f32_dpp v12, v12, v12 row_half_mirror row_mask:0xf bank_mask:0xf
  v_cvt_pk_bf16_f32 v12, v12, v12
  v_lshlrev_b32 v12, 16, v12
  v_mul_f32 v12, s72, v12
  v_cvt_pk_bf16_f32 v12, v12, v12
  v_lshlrev_b32 v59, 16, v12
  v_max_f32 v6, v6, v59
  s_waitcnt vmcnt(3)
  buffer_load_dwordx4 v[88:91], v1, s[44:47], s68 offen offset:0 nt
  buffer_load_dwordx4 v[92:95], v1, s[44:47], s68 offen offset:128 nt
  buffer_load_dwordx4 v[96:99], v1, s[44:47], s68 offen offset:256 nt
  s_add_u32 s68, s68, 12288
  v_dot2_f32_bf16 v9, v64, v24, 0
  v_dot2_f32_bf16 v10, v68, v28, 0
  v_dot2_f32_bf16 v11, v72, v32, 0
  v_dot2_f32_bf16 v9, v65, v25, v9
  v_dot2_f32_bf16 v10, v69, v29, v10
  v_dot2_f32_bf16 v11, v73, v33, v11
  v_dot2_f32_bf16 v9, v66, v26, v9
  v_dot2_f32_bf16 v10, v70, v30, v10
  v_dot2_f32_bf16 v11, v74, v34, v11
  v_dot2_f32_bf16 v9, v67, v27, v9
  v_dot2_f32_bf16 v10, v71, v31, v10
  v_dot2_f32_bf16 v11, v75, v35, v11
  s_nop 1
  v_add_f32 v12, v9, v10
  v_add_f32 v12, v12, v11
  s_nop 1
  v_add_f32_dpp v12, v12, v12 quad_perm:[1,0,3,2] row_mask:0xf bank_mask:0xf
  s_nop 1
  v_add_f32_dpp v12, v12, v12 quad_perm:[2,3,0,1] row_mask:0xf bank_mask:0xf
  s_nop 1
  v_add_f32_dpp v12, v12, v12 row_half_mirror row_mask:0xf bank_mask:0xf
  v_cvt_pk_bf16_f32 v12, v12, v12
  v_lshlrev_b32 v12, 16, v12
  v_mul_f32 v12, s72, v12
  v_cvt_pk_bf16_f32 v12, v12, v12
  v_lshlrev_b32 v60, 16, v12
  v_max_f32 v6, v6, v60
  s_waitcnt vmcnt(3)
  buffer_load_dwordx4 v[100:103], v1, s[44:47], s68 offen offset:0 nt
  buffer_load_dwordx4 v[104:107], v1, s[44:47], s68 offen offset:128 nt
  buffer_load_dwordx4 v[108:111], v1, s[44:47], s68 offen offset:256 nt
  s_add_u32 s68, s68, 47566848
  v_dot2_f32_bf16 v9, v76, v24, 0
  v_dot2_f32_bf16 v10, v80, v28, 0
  v_dot2_f32_bf16 v11, v84, v32, 0
  v_dot2_f32_bf16 v9, v77, v25, v9
  v_dot2_f32_bf16 v10, v81, v29, v10
  v_dot2_f32_bf16 v11, v85, v33, v11
  v_dot2_f32_bf16 v9, v78, v26, v9
  v_dot2_f32_bf16 v10, v82, v30, v10
  v_dot2_f32_bf16 v11, v86, v34, v11
  v_dot2_f32_bf16 v9, v79, v27, v9
  v_dot2_f32_bf16 v10, v83, v31, v10
  v_dot2_f32_bf16 v11, v87, v35, v11
  s_nop 1
  v_add_f32 v12, v9, v10
  v_add_f32 v12, v12, v11
  s_nop 1
  v_add_f32_dpp v12, v12, v12 quad_perm:[1,0,3,2] row_mask:0xf bank_mask:0xf
  s_nop 1
  v_add_f32_dpp v12, v12, v12 quad_perm:[2,3,0,1] row_mask:0xf bank_mask:0xf
  s_nop 1
  v_add_f32_dpp v12, v12, v12 row_half_mirror row_mask:0xf bank_mask:0xf
  v_cvt_pk_bf16_f32 v12, v12, v12
  v_lshlrev_b32 v12, 16, v12
  v_mul_f32 v12, s72, v12
  v_cvt_pk_bf16_f32 v12, v12, v12
  v_lshlrev_b32 v61, 16, v12
  v_max_f32 v6, v6, v61
  s_waitcnt vmcnt(3)
  buffer_load_dwordx4 v[64:67], v1, s[44:47], s68 offen offset:0 nt
  buffer_load_dwordx4 v[68:71], v1, s[44:47], s68 offen offset:128 nt
  buffer_load_dwordx4 v[72:75], v1, s[44:47], s68 offen offset:256 nt
  s_add_u32 s68, s68, 12288
  v_dot2_f32_bf16 v9, v88, v24, 0
  v_dot2_f32_bf16 v10, v92, v28, 0
  v_dot2_f32_bf16 v11, v96, v32, 0
  v_dot2_f32_bf16 v9, v89, v25, v9
  v_dot2_f32_bf16 v10, v93, v29, v10
  v_dot2_f32_bf16 v11, v97, v33, v11
  v_dot2_f32_bf16 v9, v90, v26, v9
  v_dot2_f32_bf16 v10, v94, v30, v10
  v_dot2_f32_bf16 v11, v98, v34, v11
  v_dot2_f32_bf16 v9, v91, v27, v9
  v_dot2_f32_bf16 v10, v95, v31, v10
  v_dot2_f32_bf16 v11, v99, v35, v11
  s_nop 1
  v_add_f32 v12, v9, v10
  v_add_f32 v12, v12, v11
  s_nop 1
  v_add_f32_dpp v12, v12, v12 quad_perm:[1,0,3,2] row_mask:0xf bank_mask:0xf
  s_nop 1
  v_add_f32_dpp v12, v12, v12 quad_perm:[2,3,0,1] row_mask:0xf bank_mask:0xf
  s_nop 1
  v_add_f32_dpp v12, v12, v12 row_half_mirror row_mask:0xf bank_mask:0xf
  v_cvt_pk_bf16_f32 v12, v12, v12
  v_lshlrev_b32 v12, 16, v12
  v_mul_f32 v12, s72, v12
  v_cvt_pk_bf16_f32 v12, v12, v12
  v_lshlrev_b32 v62, 16, v12
  v_max_f32 v6, v6, v62
  s_waitcnt vmcnt(3)
  buffer_load_dwordx4 v[76:79], v1, s[44:47], s68 offen offset:0 nt
  buffer_load_dwordx4 v[80:83], v1, s[44:47], s68 offen offset:128 nt
  buffer_load_dwordx4 v[84:87], v1, s[44:47], s68 offen offset:256 nt
  s_add_u32 s68, s68, 380928
  v_dot2_f32_bf16 v9, v100, v24, 0
  v_dot2_f32_bf16 v10, v104, v28, 0
  v_dot2_f32_bf16 v11, v108, v32, 0
  v_dot2_f32_bf16 v9, v101, v25, v9
  v_dot2_f32_bf16 v10, v105, v29, v10
  v_dot2_f32_bf16 v11, v109, v33, v11
  v_dot2_f32_bf16 v9, v102, v26, v9
  v_dot2_f32_bf16 v10, v106, v30, v10
  v_dot2_f32_bf16 v11, v110, v34, v11
  v_dot2_f32_bf16 v9, v103, v27, v9
  v_dot2_f32_bf16 v10, v107, v31, v10
  v_dot2_f32_bf16 v11, v111, v35, v11
  s_nop 1
  v_add_f32 v12, v9, v10
  v_add_f32 v12, v12, v11
  s_nop 1
  v_add_f32_dpp v12, v12, v12 quad_perm:[1,0,3,2] row_mask:0xf bank_mask:0xf
  s_nop 1
  v_add_f32_dpp v12, v12, v12 quad_perm:[2,3,0,1] row_mask:0xf bank_mask:0xf
  s_nop 1
  v_add_f32_dpp v12, v12, v12 row_half_mirror row_mask:0xf bank_mask:0xf
  v_cvt_pk_bf16_f32 v12, v12, v12
  v_lshlrev_b32 v12, 16, v12
  v_mul_f32 v12, s72, v12
  v_cvt_pk_bf16_f32 v12, v12, v12
  v_lshlrev_b32 v63, 16, v12
  v_max_f32 v6, v6, v63
  s_nop 1
  v_max_f32_dpp v6, v6, v6 row_ror:8 row_mask:0xf bank_mask:0xf
  v_mov_b32 v13, v6
  s_nop 1
  v_permlane16_swap_b32 v6, v13
  s_nop 1
  v_max_f32 v6, v6, v13
  v_mov_b32 v13, v6
  s_nop 1
  v_permlane32_swap_b32 v6, v13
  s_nop 1
  v_max_f32 v6, v6, v13
  v_mul_f32 v7, s71, v6
  v_sub_f32 v7, 0, v7
  s_mov_b32 exec_lo, 0x01010101
  s_mov_b32 exec_hi, 0x01010101
  ds_write_b128 v0, v[48:51] offset:0
  ds_write_b128 v0, v[52:55] offset:16
  ds_write_b128 v0, v[56:59] offset:32
  ds_write_b128 v0, v[60:63] offset:48
  ds_write_b32 v0, v7 offset:64
  s_mov_b64 exec, -1
  v_add_u32 v0, 640, v0
  v_add_u32 v16, 384, v16
  s_add_u32 s13, s13, 1
  s_mov_b32 s81, 1048576
L_q_2:
  ds_read_b32 v13, v15 offset:8
  ds_read_b128 v[24:27], v16 offset:128
  ds_read_b128 v[28:31], v16 offset:256
  ds_read_b128 v[32:35], v16 offset:384
  s_sub_u32 s81, s81, 1
  s_cselect_b32 s82, 0, s13
  s_waitcnt lgkmcnt(0)
  v_cmp_gt_u32 vcc, s82, v13
  s_cbranch_vccnz L_q_2
  s_waitcnt vmcnt(3)
  buffer_load_dwordx4 v[88:91], v1, s[44:47], s68 offen offset:0 nt
  buffer_load_dwordx4 v[92:95], v1, s[44:47], s68 offen offset:128 nt
  buffer_load_dwordx4 v[96:99], v1, s[44:47], s68 offen offset:256 nt
  s_add_u32 s68, s68, 12288
  v_dot2_f32_bf16 v9, v64, v24, 0
  v_dot2_f32_bf16 v10, v68, v28, 0
  v_dot2_f32_bf16 v11, v72, v32, 0
  v_dot2_f32_bf16 v9, v65, v25, v9
  v_dot2_f32_bf16 v10, v69, v29, v10
  v_dot2_f32_bf16 v11, v73, v33, v11
  v_dot2_f32_bf16 v9, v66, v26, v9
  v_dot2_f32_bf16 v10, v70, v30, v10
  v_dot2_f32_bf16 v11, v74, v34, v11
  v_dot2_f32_bf16 v9, v67, v27, v9
  v_dot2_f32_bf16 v10, v71, v31, v10
  v_dot2_f32_bf16 v11, v75, v35, v11
  s_nop 1
  v_add_f32 v12, v9, v10
  v_add_f32 v12, v12, v11
  s_nop 1
  v_add_f32_dpp v12, v12, v12 quad_perm:[1,0,3,2] row_mask:0xf bank_mask:0xf
  s_nop 1
  v_add_f32_dpp v12, v12, v12 quad_perm:[2,3,0,1] row_mask:0xf bank_mask:0xf
  s_nop 1
  v_add_f32_dpp v12, v12, v12 row_half_mirror row_mask:0xf bank_mask:0xf
  v_cvt_pk_bf16_f32 v12, v12, v12
  v_lshlrev_b32 v12, 16, v12
  v_mul_f32 v12, s72, v12
  v_cvt_pk_bf16_f32 v12, v12, v12
  v_lshlrev_b32 v48, 16, v12
  v_mov_b32 v6, v48
  s_waitcnt vmcnt(3)
  buffer_load_dwordx4 v[100:103], v1, s[44:47], s68 offen offset:0 nt
  buffer_load_dwordx4 v[104:107], v1, s[44:47], s68 offen offset:128 nt
  buffer_load_dwordx4 v[108:111], v1, s[44:47], s68 offen offset:256 nt
  s_add_u32 s68, s68, 380928
  v_dot2_f32_bf16 v9, v76, v24, 0
  v_dot2_f32_bf16 v10, v80, v28, 0
  v_dot2_f32_bf16 v11, v84, v32, 0
  v_dot2_f32_bf16 v9, v77, v25, v9
  v_dot2_f32_bf16 v10, v81, v29, v10
  v_dot2_f32_bf16 v11, v85, v33, v11
  v_dot2_f32_bf16 v9, v78, v26, v9
  v_dot2_f32_bf16 v10, v82, v30, v10
  v_dot2_f32_bf16 v11, v86, v34, v11
  v_dot2_f32_bf16 v9, v79, v27, v9
  v_dot2_f32_bf16 v10, v83, v31, v10
  v_dot2_f32_bf16 v11, v87, v35, v11
  s_nop 1
  v_add_f32 v12, v9, v10
  v_add_f32 v12, v12, v11
  s_nop 1
  v_add_f32_dpp v12, v12, v12 quad_perm:[1,0,3,2] row_mask:0xf bank_mask:0xf
  s_nop 1
  v_add_f32_dpp v12, v12, v12 quad_perm:[2,3,0,1] row_mask:0xf bank_mask:0xf
  s_nop 1
  v_add_f32_dpp v12, v12, v12 row_half_mirror row_mask:0xf bank_mask:0xf
  v_cvt_pk_bf16_f32 v12, v12, v12
  v_lshlrev_b32 v12, 16, v12
  v_mul_f32 v12, s72, v12
  v_cvt_pk_bf16_f32 v12, v12, v12
  v_lshlrev_b32 v49, 16, v12
  v_max_f32 v6, v6, v49
  s_sub_u32 s69, s69, 1
  s_cmp_lg_u32 s69, 0
  s_cbranch_scc1 L_loop1
  s_waitcnt vmcnt(3)
  buffer_load_dwordx4 v[64:67], v1, s[44:47], s68 offen offset:0 nt
  buffer_load_dwordx4 v[68:71], v1, s[44:47], s68 offen offset:128 nt
  buffer_load_dwordx4 v[72:75], v1, s[44:47], s68 offen offset:256 nt
  s_add_u32 s68, s68, 12288
  v_dot2_f32_bf16 v9, v88, v24, 0
  v_dot2_f32_bf16 v10, v92, v28, 0
  v_dot2_f32_bf16 v11, v96, v32, 0
  v_dot2_f32_bf16 v9, v89, v25, v9
  v_dot2_f32_bf16 v10, v93, v29, v10
  v_dot2_f32_bf16 v11, v97, v33, v11
  v_dot2_f32_bf16 v9, v90, v26, v9
  v_dot2_f32_bf16 v10, v94, v30, v10
  v_dot2_f32_bf16 v11, v98, v34, v11
  v_dot2_f32_bf16 v9, v91, v27, v9
  v_dot2_f32_bf16 v10, v95, v31, v10
  v_dot2_f32_bf16 v11, v99, v35, v11
  s_nop 1
  v_add_f32 v12, v9, v10
  v_add_f32 v12, v12, v11
  s_nop 1
  v_add_f32_dpp v12, v12, v12 quad_perm:[1,0,3,2] row_mask:0xf bank_mask:0xf
  s_nop 1
  v_add_f32_dpp v12, v12, v12 quad_perm:[2,3,0,1] row_mask:0xf bank_mask:0xf
  s_nop 1
  v_add_f32_dpp v12, v12, v12 row_half_mirror row_mask:0xf bank_mask:0xf
  v_cvt_pk_bf16_f32 v12, v12, v12
  v_lshlrev_b32 v12, 16, v12
  v_mul_f32 v12, s72, v12
  v_cvt_pk_bf16_f32 v12, v12, v12
  v_lshlrev_b32 v50, 16, v12
  v_max_f32 v6, v6, v50
  s_waitcnt vmcnt(3)
  buffer_load_dwordx4 v[76:79], v1, s[44:47], s68 offen offset:0 nt
  buffer_load_dwordx4 v[80:83], v1, s[44:47], s68 offen offset:128 nt
  buffer_load_dwordx4 v[84:87], v1, s[44:47], s68 offen offset:256 nt
  s_add_u32 s68, s68, 380928
  v_dot2_f32_bf16 v9, v100, v24, 0
  v_dot2_f32_bf16 v10, v104, v28, 0
  v_dot2_f32_bf16 v11, v108, v32, 0
  v_dot2_f32_bf16 v9, v101, v25, v9
  v_dot2_f32_bf16 v10, v105, v29, v10
  v_dot2_f32_bf16 v11, v109, v33, v11
  v_dot2_f32_bf16 v9, v102, v26, v9
  v_dot2_f32_bf16 v10, v106, v30, v10
  v_dot2_f32_bf16 v11, v110, v34, v11
  v_dot2_f32_bf16 v9, v103, v27, v9
  v_dot2_f32_bf16 v10, v107, v31, v10
  v_dot2_f32_bf16 v11, v111, v35, v11
  s_nop 1
  v_add_f32 v12, v9, v10
  v_add_f32 v12, v12, v11
  s_nop 1
  v_add_f32_dpp v12, v12, v12 quad_perm:[1,0,3,2] row_mask:0xf bank_mask:0xf
  s_nop 1
  v_add_f32_dpp v12, v12, v12 quad_perm:[2,3,0,1] row_mask:0xf bank_mask:0xf
  s_nop 1
  v_add_f32_dpp v12, v12, v12 row_half_mirror row_mask:0xf bank_mask:0xf
  v_cvt_pk_bf16_f32 v12, v12, v12
  v_lshlrev_b32 v12, 16, v12
  v_mul_f32 v12, s72, v12
  v_cvt_pk_bf16_f32 v12, v12, v12
  v_lshlrev_b32 v51, 16, v12
  v_max_f32 v6, v6, v51
  s_waitcnt vmcnt(3)
  buffer_load_dwordx4 v[88:91], v1, s[44:47], s68 offen offset:0 nt
  buffer_load_dwordx4 v[92:95], v1, s[44:47], s68 offen offset:128 nt
  buffer_load_dwordx4 v[96:99], v1, s[44:47], s68 offen offset:256 nt
  s_add_u32 s68, s68, 12288
  v_dot2_f32_bf16 v9, v64, v24, 0
  v_dot2_f32_bf16 v10, v68, v28, 0
  v_dot2_f32_bf16 v11, v72, v32, 0
  v_dot2_f32_bf16 v9, v65, v25, v9
  v_dot2_f32_bf16 v10, v69, v29, v10
  v_dot2_f32_bf16 v11, v73, v33, v11
  v_dot2_f32_bf16 v9, v66, v26, v9
  v_dot2_f32_bf16 v10, v70, v30, v10
  v_dot2_f32_bf16 v11, v74, v34, v11
  v_dot2_f32_bf16 v9, v67, v27, v9
  v_dot2_f32_bf16 v10, v71, v31, v10
  v_dot2_f32_bf16 v11, v75, v35, v11
  s_nop 1
  v_add_f32 v12, v9, v10
  v_add_f32 v12, v12, v11
  s_nop 1
  v_add_f32_dpp v12, v12, v12 quad_perm:[1,0,3,2] row_mask:0xf bank_mask:0xf
  s_nop 1
  v_add_f32_dpp v12, v12, v12 quad_perm:[2,3,0,1] row_mask:0xf bank_mask:0xf
  s_nop 1
  v_add_f32_dpp v12, v12, v12 row_half_mirror row_mask:0xf bank_mask:0xf
  v_cvt_pk_bf16_f32 v12, v12, v12
  v_lshlrev_b32 v12, 16, v12
  v_mul_f32 v12, s72, v12
  v_cvt_pk_bf16_f32 v12, v12, v12
  v_lshlrev_b32 v52, 16, v12
  v_max_f32 v6, v6, v52
  s_waitcnt vmcnt(3)
  buffer_load_dwordx4 v[100:103], v1, s[44:47], s68 offen offset:0 nt
  buffer_load_dwordx4 v[104:107], v1, s[44:47], s68 offen offset:128 nt
  buffer_load_dwordx4 v[108:111], v1, s[44:47], s68 offen offset:256 nt
  s_add_u32 s68, s68, 380928
  v_dot2_f32_bf16 v9, v76, v24, 0
  v_dot2_f32_bf16 v10, v80, v28, 0
  v_dot2_f32_bf16 v11, v84, v32, 0
  v_dot2_f32_bf16 v9, v77, v25, v9
  v_dot2_f32_bf16 v10, v81, v29, v10
  v_dot2_f32_bf16 v11, v85, v33, v11
  v_dot2_f32_bf16 v9, v78, v26, v9
  v_dot2_f32_bf16 v10, v82, v30, v10
  v_dot2_f32_bf16 v11, v86, v34, v11
  v_dot2_f32_bf16 v9, v79, v27, v9
  v_dot2_f32_bf16 v10, v83, v31, v10
  v_dot2_f32_bf16 v11, v87, v35, v11
  s_nop 1
  v_add_f32 v12, v9, v10
  v_add_f32 v12, v12, v11
  s_nop 1
  v_add_f32_dpp v12, v12, v12 quad_perm:[1,0,3,2] row_mask:0xf bank_mask:0xf
  s_nop 1
  v_add_f32_dpp v12, v12, v12 quad_perm:[2,3,0,1] row_mask:0xf bank_mask:0xf
  s_nop 1
  v_add_f32_dpp v12, v12, v12 row_half_mirror row_mask:0xf bank_mask:0xf
  v_cvt_pk_bf16_f32 v12, v12, v12
  v_lshlrev_b32 v12, 16, v12
  v_mul_f32 v12, s72, v12
  v_cvt_pk_bf16_f32 v12, v12, v12
  v_lshlrev_b32 v53, 16, v12
  v_max_f32 v6, v6, v53
  s_waitcnt vmcnt(3)
  buffer_load_dwordx4 v[64:67], v1, s[44:47], s68 offen offset:0 nt
  buffer_load_dwordx4 v[68:71], v1, s[44:47], s68 offen offset:128 nt
  buffer_load_dwordx4 v[72:75], v1, s[44:47], s68 offen offset:256 nt
  s_add_u32 s68, s68, 12288
  v_dot2_f32_bf16 v9, v88, v24, 0
  v_dot2_f32_bf16 v10, v92, v28, 0
  v_dot2_f32_bf16 v11, v96, v32, 0
  v_dot2_f32_bf16 v9, v89, v25, v9
  v_dot2_f32_bf16 v10, v93, v29, v10
  v_dot2_f32_bf16 v11, v97, v33, v11
  v_dot2_f32_bf16 v9, v90, v26, v9
  v_dot2_f32_bf16 v10, v94, v30, v10
  v_dot2_f32_bf16 v11, v98, v34, v11
  v_dot2_f32_bf16 v9, v91, v27, v9
  v_dot2_f32_bf16 v10, v95, v31, v10
  v_dot2_f32_bf16 v11, v99, v35, v11
  s_nop 1
  v_add_f32 v12, v9, v10
  v_add_f32 v12, v12, v11
  s_nop 1
  v_add_f32_dpp v12, v12, v12 quad_perm:[1,0,3,2] row_mask:0xf bank_mask:0xf
  s_nop 1
  v_add_f32_dpp v12, v12, v12 quad_perm:[2,3,0,1] row_mask:0xf bank_mask:0xf
  s_nop 1
  v_add_f32_dpp v12, v12, v12 row_half_mirror row_mask:0xf bank_mask:0xf
  v_cvt_pk_bf16_f32 v12, v12, v12
  v_lshlrev_b32 v12, 16, v12
  v_mul_f32 v12, s72, v12
  v_cvt_pk_bf16_f32 v12, v12, v12
  v_lshlrev_b32 v54, 16, v12
  v_max_f32 v6, v6, v54
  s_waitcnt vmcnt(3)
  buffer_load_dwordx4 v[76:79], v1, s[44:47], s68 offen offset:0 nt
  buffer_load_dwordx4 v[80:83], v1, s[44:47], s68 offen offset:128 nt
  buffer_load_dwordx4 v[84:87], v1, s[44:47], s68 offen offset:256 nt
  s_add_u32 s68, s68, 380928
  v_dot2_f32_bf16 v9, v100, v24, 0
  v_dot2_f32_bf16 v10, v104, v28, 0
  v_dot2_f32_bf16 v11, v108, v32, 0
  v_dot2_f32_bf16 v9, v101, v25, v9
  v_dot2_f32_bf16 v10, v105, v29, v10
  v_dot2_f32_bf16 v11, v109, v33, v11
  v_dot2_f32_bf16 v9, v102, v26, v9
  v_dot2_f32_bf16 v10, v106, v30, v10
  v_dot2_f32_bf16 v11, v110, v34, v11
  v_dot2_f32_bf16 v9, v103, v27, v9
  v_dot2_f32_bf16 v10, v107, v31, v10
  v_dot2_f32_bf16 v11, v111, v35, v11
  s_nop 1
  v_add_f32 v12, v9, v10
  v_add_f32 v12, v12, v11
  s_nop 1
  v_add_f32_dpp v12, v12, v12 quad_perm:[1,0,3,2] row_mask:0xf bank_mask:0xf
  s_nop 1
  v_add_f32_dpp v12, v12, v12 quad_perm:[2,3,0,1] row_mask:0xf bank_mask:0xf
  s_nop 1
  v_add_f32_dpp v12, v12, v12 row_half_mirror row_mask:0xf bank_mask:0xf
  v_cvt_pk_bf16_f32 v12, v12, v12
  v_lshlrev_b32 v12, 16, v12
  v_mul_f32 v12, s72, v12
  v_cvt_pk_bf16_f32 v12, v12, v12
  v_lshlrev_b32 v55, 16, v12
  v_max_f32 v6, v6, v55
  s_waitcnt vmcnt(3)
  buffer_load_dwordx4 v[88:91], v1, s[44:47], s68 offen offset:0 nt
  buffer_load_dwordx4 v[92:95], v1, s[44:47], s68 offen offset:128 nt
  buffer_load_dwordx4 v[96:99], v1, s[44:47], s68 offen offset:256 nt
  s_add_u32 s68, s68, 12288
  v_dot2_f32_bf16 v9, v64, v24, 0
  v_dot2_f32_bf16 v10, v68, v28, 0
  v_dot2_f32_bf16 v11, v72, v32, 0
  v_dot2_f32_bf16 v9, v65, v25, v9
  v_dot2_f32_bf16 v10, v69, v29, v10
  v_dot2_f32_bf16 v11, v73, v33, v11
  v_dot2_f32_bf16 v9, v66, v26, v9
  v_dot2_f32_bf16 v10, v70, v30, v10
  v_dot2_f32_bf16 v11, v74, v34, v11
  v_dot2_f32_bf16 v9, v67, v27, v9
  v_dot2_f32_bf16 v10, v71, v31, v10
  v_dot2_f32_bf16 v11, v75, v35, v11
  s_nop 1
  v_add_f32 v12, v9, v10
  v_add_f32 v12, v12, v11
  s_nop 1
  v_add_f32_dpp v12, v12, v12 quad_perm:[1,0,3,2] row_mask:0xf bank_mask:0xf
  s_nop 1
  v_add_f32_dpp v12, v12, v12 quad_perm:[2,3,0,1] row_mask:0xf bank_mask:0xf
  s_nop 1
  v_add_f32_dpp v12, v12, v12 row_half_mirror row_mask:0xf bank_mask:0xf
  v_cvt_pk_bf16_f32 v12, v12, v12
  v_lshlrev_b32 v12, 16, v12
  v_mul_f32 v12, s72, v12
  v_cvt_pk_bf16_f32 v12, v12, v12
  v_lshlrev_b32 v56, 16, v12
  v_max_f32 v6, v6, v56
  s_waitcnt vmcnt(3)
  buffer_load_dwordx4 v[100:103], v1, s[44:47], s68 offen offset:0 nt
  buffer_load_dwordx4 v[104:107], v1, s[44:47], s68 offen offset:128 nt
  buffer_load_dwordx4 v[108:111], v1, s[44:47], s68 offen offset:256 nt
  s_add_u32 s68, s68, 380928
  v_dot2_f32_bf16 v9, v76, v24, 0
  v_dot2_f32_bf16 v10, v80, v28, 0
  v_dot2_f32_bf16 v11, v84, v32, 0
  v_dot2_f32_bf16 v9, v77, v25, v9
  v_dot2_f32_bf16 v10, v81, v29, v10
  v_dot2_f32_bf16 v11, v85, v33, v11
  v_dot2_f32_bf16 v9, v78, v26, v9
  v_dot2_f32_bf16 v10, v82, v30, v10
  v_dot2_f32_bf16 v11, v86, v34, v11
  v_dot2_f32_bf16 v9, v79, v27, v9
  v_dot2_f32_bf16 v10, v83, v31, v10
  v_dot2_f32_bf16 v11, v87, v35, v11
  s_nop 1
  v_add_f32 v12, v9, v10
  v_add_f32 v12, v12, v11
  s_nop 1
  v_add_f32_dpp v12, v12, v12 quad_perm:[1,0,3,2] row_mask:0xf bank_mask:0xf
  s_nop 1
  v_add_f32_dpp v12, v12, v12 quad_perm:[2,3,0,1] row_mask:0xf bank_mask:0xf
  s_nop 1
  v_add_f32_dpp v12, v12, v12 row_half_mirror row_mask:0xf bank_mask:0xf
  v_cvt_pk_bf16_f32 v12, v12, v12
  v_lshlrev_b32 v12, 16, v12
  v_mul_f32 v12, s72, v12
  v_cvt_pk_bf16_f32 v12, v12, v12
  v_lshlrev_b32 v57, 16, v12
  v_max_f32 v6, v6, v57
  s_waitcnt vmcnt(3)
  buffer_load_dwordx4 v[64:67], v1, s[44:47], s68 offen offset:0 nt
  buffer_load_dwordx4 v[68:71], v1, s[44:47], s68 offen offset:128 nt
  buffer_load_dwordx4 v[72:75], v1, s[44:47], s68 offen offset:256 nt
  s_add_u32 s68, s68, 12288
  v_dot2_f32_bf16 v9, v88, v24, 0
  v_dot2_f32_bf16 v10, v92, v28, 0
  v_dot2_f32_bf16 v11, v96, v32, 0
  v_dot2_f32_bf16 v9, v89, v25, v9
  v_dot2_f32_bf16 v10, v93, v29, v10
  v_dot2_f32_bf16 v11, v97, v33, v11
  v_dot2_f32_bf16 v9, v90, v26, v9
  v_dot2_f32_bf16 v10, v94, v30, v10
  v_dot2_f32_bf16 v11, v98, v34, v11
  v_dot2_f32_bf16 v9, v91, v27, v9
  v_dot2_f32_bf16 v10, v95, v31, v10
  v_dot2_f32_bf16 v11, v99, v35, v11
  s_nop 1
  v_add_f32 v12, v9, v10
  v_add_f32 v12, v12, v11
  s_nop 1
  v_add_f32_dpp v12, v12, v12 quad_perm:[1,0,3,2] row_mask:0xf bank_mask:0xf
  s_nop 1
  v_add_f32_dpp v12, v12, v12 quad_perm:[2,3,0,1] row_mask:0xf bank_mask:0xf
  s_nop 1
  v_add_f32_dpp v12, v12, v12 row_half_mirror row_mask:0xf bank_mask:0xf
  v_cvt_pk_bf16_f32 v12, v12, v12
  v_lshlrev_b32 v12, 16, v12
  v_mul_f32 v12, s72, v12
  v_cvt_pk_bf16_f32 v12, v12, v12
  v_lshlrev_b32 v58, 16, v12
  v_max_f32 v6, v6, v58
  s_waitcnt vmcnt(3)
  buffer_load_dwordx4 v[76:79], v1, s[44:47], s68 offen offset:0 nt
  buffer_load_dwordx4 v[80:83], v1, s[44:47], s68 offen offset:128 nt
  buffer_load_dwordx4 v[84:87], v1, s[44:47], s68 offen offset:256 nt
  s_add_u32 s68, s68, 380928
  v_dot2_f32_bf16 v9, v100, v24, 0
  v_dot2_f32_bf16 v10, v104, v28, 0
  v_dot2_f32_bf16 v11, v108, v32, 0
  v_dot2_f32_bf16 v9, v101, v25, v9
  v_dot2_f32_bf16 v10, v105, v29, v10
  v_dot2_f32_bf16 v11, v109, v33, v11
  v_dot2_f32_bf16 v9, v102, v26, v9
  v_dot2_f32_bf16 v10, v106, v30, v10
  v_dot2_f32_bf16 v11, v110, v34, v11
  v_dot2_f32_bf16 v9, v103, v27, v9
  v_dot2_f32_bf16 v10, v107, v31, v10
  v_dot2_f32_bf16 v11, v111, v35, v11
  s_nop 1
  v_add_f32 v12, v9, v10
  v_add_f32 v12, v12, v11
  s_nop 1
  v_add_f32_dpp v12, v12, v12 quad_perm:[1,0,3,2] row_mask:0xf bank_mask:0xf
  s_nop 1
  v_add_f32_dpp v12, v12, v12 quad_perm:[2,3,0,1] row_mask:0xf bank_mask:0xf
  s_nop 1
  v_add_f32_dpp v12, v12, v12 row_half_mirror row_mask:0xf bank_mask:0xf
  v_cvt_pk_bf16_f32 v12, v12, v12
  v_lshlrev_b32 v12, 16, v12
  v_mul_f32 v12, s72, v12
  v_cvt_pk_bf16_f32 v12, v12, v12
  v_lshlrev_b32 v59, 16, v12
  v_max_f32 v6, v6, v59
  s_waitcnt vmcnt(3)
  buffer_load_dwordx4 v[88:91], v1, s[44:47], s68 offen offset:0 nt
  buffer_load_dwordx4 v[92:95], v1, s[44:47], s68 offen offset:128 nt
  buffer_load_dwordx4 v[96:99], v1, s[44:47], s68 offen offset:256 nt
  s_add_u32 s68, s68, 12288
  v_dot2_f32_bf16 v9, v64, v24, 0
  v_dot2_f32_bf16 v10, v68, v28, 0
  v_dot2_f32_bf16 v11, v72, v32, 0
  v_dot2_f32_bf16 v9, v65, v25, v9
  v_dot2_f32_bf16 v10, v69, v29, v10
  v_dot2_f32_bf16 v11, v73, v33, v11
  v_dot2_f32_bf16 v9, v66, v26, v9
  v_dot2_f32_bf16 v10, v70, v30, v10
  v_dot2_f32_bf16 v11, v74, v34, v11
  v_dot2_f32_bf16 v9, v67, v27, v9
  v_dot2_f32_bf16 v10, v71, v31, v10
  v_dot2_f32_bf16 v11, v75, v35, v11
  s_nop 1
  v_add_f32 v12, v9, v10
  v_add_f32 v12, v12, v11
  s_nop 1
  v_add_f32_dpp v12, v12, v12 quad_perm:[1,0,3,2] row_mask:0xf bank_mask:0xf
  s_nop 1
  v_add_f32_dpp v12, v12, v12 quad_perm:[2,3,0,1] row_mask:0xf bank_mask:0xf
  s_nop 1
  v_add_f32_dpp v12, v12, v12 row_half_mirror row_mask:0xf bank_mask:0xf
  v_cvt_pk_bf16_f32 v12, v12, v12
  v_lshlrev_b32 v12, 16, v12
  v_mul_f32 v12, s72, v12
  v_cvt_pk_bf16_f32 v12, v12, v12
  v_lshlrev_b32 v60, 16, v12
  v_max_f32 v6, v6, v60
  s_waitcnt vmcnt(3)
  buffer_load_dwordx4 v[100:103], v1, s[44:47], s68 offen offset:0 nt
  buffer_load_dwordx4 v[104:107], v1, s[44:47], s68 offen offset:128 nt
  buffer_load_dwordx4 v[108:111], v1, s[44:47], s68 offen offset:256 nt
  s_mov_b32 s68, s10
  v_dot2_f32_bf16 v9, v76, v24, 0
  v_dot2_f32_bf16 v10, v80, v28, 0
  v_dot2_f32_bf16 v11, v84, v32, 0
  v_dot2_f32_bf16 v9, v77, v25, v9
  v_dot2_f32_bf16 v10, v81, v29, v10
  v_dot2_f32_bf16 v11, v85, v33, v11
  v_dot2_f32_bf16 v9, v78, v26, v9
  v_dot2_f32_bf16 v10, v82, v30, v10
  v_dot2_f32_bf16 v11, v86, v34, v11
  v_dot2_f32_bf16 v9, v79, v27, v9
  v_dot2_f32_bf16 v10, v83, v31, v10
  v_dot2_f32_bf16 v11, v87, v35, v11
  s_nop 1
  v_add_f32 v12, v9, v10
  v_add_f32 v12, v12, v11
  s_nop 1
  v_add_f32_dpp v12, v12, v12 quad_perm:[1,0,3,2] row_mask:0xf bank_mask:0xf
  s_nop 1
  v_add_f32_dpp v12, v12, v12 quad_perm:[2,3,0,1] row_mask:0xf bank_mask:0xf
  s_nop 1
  v_add_f32_dpp v12, v12, v12 row_half_mirror row_mask:0xf bank_mask:0xf
  v_cvt_pk_bf16_f32 v12, v12, v12
  v_lshlrev_b32 v12, 16, v12
  v_mul_f32 v12, s72, v12
  v_cvt_pk_bf16_f32 v12, v12, v12
  v_lshlrev_b32 v61, 16, v12
  v_max_f32 v6, v6, v61
  s_waitcnt vmcnt(3)
  buffer_load_dwordx4 v[64:67], v1, s[44:47], s68 offen offset:0 nt
  buffer_load_dwordx4 v[68:71], v1, s[44:47], s68 offen offset:128 nt
  buffer_load_dwordx4 v[72:75], v1, s[44:47], s68 offen offset:256 nt
  s_add_u32 s68, s68, 12288
  v_dot2_f32_bf16 v9, v88, v24, 0
  v_dot2_f32_bf16 v10, v92, v28, 0
  v_dot2_f32_bf16 v11, v96, v32, 0
  v_dot2_f32_bf16 v9, v89, v25, v9
  v_dot2_f32_bf16 v10, v93, v29, v10
  v_dot2_f32_bf16 v11, v97, v33, v11
  v_dot2_f32_bf16 v9, v90, v26, v9
  v_dot2_f32_bf16 v10, v94, v30, v10
  v_dot2_f32_bf16 v11, v98, v34, v11
  v_dot2_f32_bf16 v9, v91, v27, v9
  v_dot2_f32_bf16 v10, v95, v31, v10
  v_dot2_f32_bf16 v11, v99, v35, v11
  s_nop 1
  v_add_f32 v12, v9, v10
  v_add_f32 v12, v12, v11
  s_nop 1
  v_add_f32_dpp v12, v12, v12 quad_perm:[1,0,3,2] row_mask:0xf bank_mask:0xf
  s_nop 1
  v_add_f32_dpp v12, v12, v12 quad_perm:[2,3,0,1] row_mask:0xf bank_mask:0xf
  s_nop 1
  v_add_f32_dpp v12, v12, v12 row_half_mirror row_mask:0xf bank_mask:0xf
  v_cvt_pk_bf16_f32 v12, v12, v12
  v_lshlrev_b32 v12, 16, v12
  v_mul_f32 v12, s72, v12
  v_cvt_pk_bf16_f32 v12, v12, v12
  v_lshlrev_b32 v62, 16, v12
  v_max_f32 v6, v6, v62
  s_waitcnt vmcnt(3)
  buffer_load_dwordx4 v[76:79], v1, s[44:47], s68 offen offset:0 nt
  buffer_load_dwordx4 v[80:83], v1, s[44:47], s68 offen offset:128 nt
  buffer_load_dwordx4 v[84:87], v1, s[44:47], s68 offen offset:256 nt
  s_add_u32 s68, s68, 12288
  v_dot2_f32_bf16 v9, v100, v24, 0
  v_dot2_f32_bf16 v10, v104, v28, 0
  v_dot2_f32_bf16 v11, v108, v32, 0
  v_dot2_f32_bf16 v9, v101, v25, v9
  v_dot2_f32_bf16 v10, v105, v29, v10
  v_dot2_f32_bf16 v11, v109, v33, v11
  v_dot2_f32_bf16 v9, v102, v26, v9
  v_dot2_f32_bf16 v10, v106, v30, v10
  v_dot2_f32_bf16 v11, v110, v34, v11
  v_dot2_f32_bf16 v9, v103, v27, v9
  v_dot2_f32_bf16 v10, v107, v31, v10
  v_dot2_f32_bf16 v11, v111, v35, v11
  s_nop 1
  v_add_f32 v12, v9, v10
  v_add_f32 v12, v12, v11
  s_nop 1
  v_add_f32_dpp v12, v12, v12 quad_perm:[1,0,3,2] row_mask:0xf bank_mask:0xf
  s_nop 1
  v_add_f32_dpp v12, v12, v12 quad_perm:[2,3,0,1] row_mask:0xf bank_mask:0xf
  s_nop 1
  v_add_f32_dpp v12, v12, v12 row_half_mirror row_mask:0xf bank_mask:0xf
  v_cvt_pk_bf16_f32 v12, v12, v12
  v_lshlrev_b32 v12, 16, v12
  v_mul_f32 v12, s72, v12
  v_cvt_pk_bf16_f32 v12, v12, v12
  v_lshlrev_b32 v63, 16, v12
  v_max_f32 v6, v6, v63
  s_nop 1
  v_max_f32_dpp v6, v6, v6 row_ror:8 row_mask:0xf bank_mask:0xf
  v_mov_b32 v13, v6
  s_nop 1
  v_permlane16_swap_b32 v6, v13
  s_nop 1
  v_max_f32 v6, v6, v13
  v_mov_b32 v13, v6
  s_nop 1
  v_permlane32_swap_b32 v6, v13
  s_nop 1
  v_max_f32 v6, v6, v13
  v_mul_f32 v7, s71, v6
  v_sub_f32 v7, 0, v7
  s_mov_b32 exec_lo, 0x01010101
  s_mov_b32 exec_hi, 0x01010101
  ds_write_b128 v0, v[48:51] offset:0
  ds_write_b128 v0, v[52:55] offset:16
  ds_write_b128 v0, v[56:59] offset:32
  ds_write_b128 v0, v[60:63] offset:48
  ds_write_b32 v0, v7 offset:64
  s_mov_b64 exec, -1
  v_add_u32 v0, 640, v0
  v_add_u32 v16, 384, v16
  s_add_u32 s13, s13, 1
  s_mov_b32 s81, 1048576
L_q_7:
  ds_read_b32 v13, v15 offset:8
  ds_read_b128 v[24:27], v16 offset:128
  ds_read_b128 v[28:31], v16 offset:256
  ds_read_b128 v[32:35], v16 offset:384
  s_sub_u32 s81, s81, 1
  s_cselect_b32 s82, 0, s13
  s_waitcnt lgkmcnt(0)
  v_cmp_gt_u32 vcc, s82, v13
  s_cbranch_vccnz L_q_7
  s_waitcnt vmcnt(3)
  buffer_load_dwordx4 v[88:91], v1, s[44:47], s68 offen offset:0 nt
  buffer_load_dwordx4 v[92:95], v1, s[44:47], s68 offen offset:128 nt
  buffer_load_dwordx4 v[96:99], v1, s[44:47], s68 offen offset:256 nt
  s_add_u32 s68, s68, 12288
  v_dot2_f32_bf16 v9, v64, v24, 0
  v_dot2_f32_bf16 v10, v68, v28, 0
  v_dot2_f32_bf16 v11, v72, v32, 0
  v_dot2_f32_bf16 v9, v65, v25, v9
  v_dot2_f32_bf16 v10, v69, v29, v10
  v_dot2_f32_bf16 v11, v73, v33, v11
  v_dot2_f32_bf16 v9, v66, v26, v9
  v_dot2_f32_bf16 v10, v70, v30, v10
  v_dot2_f32_bf16 v11, v74, v34, v11
  v_dot2_f32_bf16 v9, v67, v27, v9
  v_dot2_f32_bf16 v10, v71, v31, v10
  v_dot2_f32_bf16 v11, v75, v35, v11
  s_nop 1
  v_add_f32 v12, v9, v10
  v_add_f32 v12, v12, v11
  s_nop 1
  v_add_f32_dpp v12, v12, v12 quad_perm:[1,0,3,2] row_mask:0xf bank_mask:0xf
  s_nop 1
  v_add_f32_dpp v12, v12, v12 quad_perm:[2,3,0,1] row_mask:0xf bank_mask:0xf
  s_nop 1
  v_add_f32_dpp v12, v12, v12 row_half_mirror row_mask:0xf bank_mask:0xf
  v_cvt_pk_bf16_f32 v12, v12, v12
  v_lshlrev_b32 v12, 16, v12
  v_mul_f32 v12, s72, v12
  v_cvt_pk_bf16_f32 v12, v12, v12
  v_lshlrev_b32 v48, 16, v12
  v_mov_b32 v6, v48
  s_waitcnt vmcnt(3)
  buffer_load_dwordx4 v[100:103], v1, s[44:47], s68 offen offset:0 nt
  buffer_load_dwordx4 v[104:107], v1, s[44:47], s68 offen offset:128 nt
  buffer_load_dwordx4 v[108:111], v1, s[44:47], s68 offen offset:256 nt
  s_mov_b32 s68, s9
  v_dot2_f32_bf16 v9, v76, v24, 0
  v_dot2_f32_bf16 v10, v80, v28, 0
  v_dot2_f32_bf16 v11, v84, v32, 0
  v_dot2_f32_bf16 v9, v77, v25, v9
  v_dot2_f32_bf16 v10, v81, v29, v10
  v_dot2_f32_bf16 v11, v85, v33, v11
  v_dot2_f32_bf16 v9, v78, v26, v9
  v_dot2_f32_bf16 v10, v82, v30, v10
  v_dot2_f32_bf16 v11, v86, v34, v11
  v_dot2_f32_bf16 v9, v79, v27, v9
  v_dot2_f32_bf16 v10, v83, v31, v10
  v_dot2_f32_bf16 v11, v87, v35, v11
  s_nop 1
  v_add_f32 v12, v9, v10
  v_add_f32 v12, v12, v11
  s_nop 1
  v_add_f32_dpp v12, v12, v12 quad_perm:[1,0,3,2] row_mask:0xf bank_mask:0xf
  s_nop 1
  v_add_f32_dpp v12, v12, v12 quad_perm:[2,3,0,1] row_mask:0xf bank_mask:0xf
  s_nop 1
  v_add_f32_dpp v12, v12, v12 row_half_mirror row_mask:0xf bank_mask:0xf
  v_cvt_pk_bf16_f32 v12, v12, v12
  v_lshlrev_b32 v12, 16, v12
  v_mul_f32 v12, s72, v12
  v_cvt_pk_bf16_f32 v12, v12, v12
  v_lshlrev_b32 v49, 16, v12
  v_max_f32 v6, v6, v49
  s_waitcnt vmcnt(3)
  buffer_load_dwordx4 v[64:67], v1, s[48:51], s68 offen offset:0 nt
  buffer_load_dwordx4 v[68:71], v1, s[48:51], s68 offen offset:128 nt
  buffer_load_dwordx4 v[72:75], v1, s[48:51], s68 offen offset:256 nt
  s_add_u32 s68, s68, 12288
  v_dot2_f32_bf16 v9, v88, v24, 0
  v_dot2_f32_bf16 v10, v92, v28, 0
  v_dot2_f32_bf16 v11, v96, v32, 0
  v_dot2_f32_bf16 v9, v89, v25, v9
  v_dot2_f32_bf16 v10, v93, v29, v10
  v_dot2_f32_bf16 v11, v97, v33, v11
  v_dot2_f32_bf16 v9, v90, v26, v9
  v_dot2_f32_bf16 v10, v94, v30, v10
  v_dot2_f32_bf16 v11, v98, v34, v11
  v_dot2_f32_bf16 v9, v91, v27, v9
  v_dot2_f32_bf16 v10, v95, v31, v10
  v_dot2_f32_bf16 v11, v99, v35, v11
  s_nop 1
  v_add_f32 v12, v9, v10
  v_add_f32 v12, v12, v11
  s_nop 1
  v_add_f32_dpp v12, v12, v12 quad_perm:[1,0,3,2] row_mask:0xf bank_mask:0xf
  s_nop 1
  v_add_f32_dpp v12, v12, v12 quad_perm:[2,3,0,1] row_mask:0xf bank_mask:0xf
  s_nop 1
  v_add_f32_dpp v12, v12, v12 row_half_mirror row_mask:0xf bank_mask:0xf
  v_cvt_pk_bf16_f32 v12, v12, v12
  v_lshlrev_b32 v12, 16, v12
  v_mul_f32 v12, s72, v12
  v_cvt_pk_bf16_f32 v12, v12, v12
  v_lshlrev_b32 v50, 16, v12
  v_max_f32 v6, v6, v50
  s_waitcnt vmcnt(3)
  buffer_load_dwordx4 v[76:79], v1, s[48:51], s68 offen offset:0 nt
  buffer_load_dwordx4 v[80:83], v1, s[48:51], s68 offen offset:128 nt
  buffer_load_dwordx4 v[84:87], v1, s[48:51], s68 offen offset:256 nt
  s_add_u32 s68, s68, 380928
  v_dot2_f32_bf16 v9, v100, v24, 0
  v_dot2_f32_bf16 v10, v104, v28, 0
  v_dot2_f32_bf16 v11, v108, v32, 0
  v_dot2_f32_bf16 v9, v101, v25, v9
  v_dot2_f32_bf16 v10, v105, v29, v10
  v_dot2_f32_bf16 v11, v109, v33, v11
  v_dot2_f32_bf16 v9, v102, v26, v9
  v_dot2_f32_bf16 v10, v106, v30, v10
  v_dot2_f32_bf16 v11, v110, v34, v11
  v_dot2_f32_bf16 v9, v103, v27, v9
  v_dot2_f32_bf16 v10, v107, v31, v10
  v_dot2_f32_bf16 v11, v111, v35, v11
  s_nop 1
  v_add_f32 v12, v9, v10
  v_add_f32 v12, v12, v11
  s_nop 1
  v_add_f32_dpp v12, v12, v12 quad_perm:[1,0,3,2] row_mask:0xf bank_mask:0xf
  s_nop 1
  v_add_f32_dpp v12, v12, v12 quad_perm:[2,3,0,1] row_mask:0xf bank_mask:0xf
  s_nop 1
  v_add_f32_dpp v12, v12, v12 row_half_mirror row_mask:0xf bank_mask:0xf
  v_cvt_pk_bf16_f32 v12, v12, v12
  v_lshlrev_b32 v12, 16, v12
  v_mul_f32 v12, s72, v12
  v_cvt_pk_bf16_f32 v12, v12, v12
  v_lshlrev_b32 v51, 16, v12
  v_max_f32 v6, v6, v51
  s_nop 1
  v_max_f32_dpp v6, v6, v6 row_ror:8 row_mask:0xf bank_mask:0xf
  v_mov_b32 v13, v6
  s_nop 1
  v_permlane16_swap_b32 v6, v13
  s_nop 1
  v_max_f32 v6, v6, v13
  v_mov_b32 v13, v6
  s_nop 1
  v_permlane32_swap_b32 v6, v13
  s_nop 1
  v_max_f32 v6, v6, v13
  v_mul_f32 v7, s71, v6
  v_sub_f32 v7, 0, v7
  s_mov_b32 exec_lo, 0x01010101
  s_mov_b32 exec_hi, 0x01010101
  ds_write_b128 v0, v[48:51] offset:0
  ds_write_b128 v0, v[52:55] offset:16
  ds_write_b128 v0, v[56:59] offset:32
  ds_write_b128 v0, v[60:63] offset:48
  ds_write_b32 v0, v7 offset:64
  s_mov_b64 exec, -1
  v_add_u32 v0, 640, v0
  v_subrev_u32 v0, 5120, v0
  ds_read_b128 v[48:51], v0 offset:0
  ds_read_b128 v[52:55], v0 offset:16
  ds_read_b128 v[56:59], v0 offset:32
  ds_read_b128 v[60:63], v0 offset:48
  ds_read_b32 v7, v0 offset:64
  v_add_u32 v0, 640, v0
  s_waitcnt lgkmcnt(0)
  v_fma_f32 v14, v48, s71, v7
  v_exp_f32 v14, v14
  s_nop 0
  v_cvt_pk_bf16_f32 v13, v14, v14
  v_mov_b32 v8, v14
  v_and_b32 v20, v13, v2
  v_and_b32 v21, v13, v3
  v_and_b32 v22, v13, v4
  v_and_b32 v23, v13, v5
  s_waitcnt vmcnt(3)
  buffer_load_dwordx4 v[88:91], v1, s[48:51], s68 offen offset:0 nt
  buffer_load_dwordx4 v[92:95], v1, s[48:51], s68 offen offset:128 nt
  buffer_load_dwordx4 v[96:99], v1, s[48:51], s68 offen offset:256 nt
  s_add_u32 s68, s68, 12288
  s_nop 1
  v_mfma_f32_16x16x32_bf16 v[36:39], v[20:23], v[64:67], 0
  v_mfma_f32_16x16x32_bf16 v[40:43], v[20:23], v[68:71], 0
  v_mfma_f32_16x16x32_bf16 v[44:47], v[20:23], v[72:75], 0
  s_mov_b32 s69, 6
L_loop2:
  v_fma_f32 v14, v49, s71, v7
  v_exp_f32 v14, v14
  s_nop 0
  v_cvt_pk_bf16_f32 v13, v14, v14
  v_add_f32 v8, v8, v14
  v_and_b32 v20, v13, v2
  v_and_b32 v21, v13, v3
  v_and_b32 v22, v13, v4
  v_and_b32 v23, v13, v5
  s_waitcnt vmcnt(3)
  buffer_load_dwordx4 v[100:103], v1, s[48:51], s68 offen offset:0 nt
  buffer_load_dwordx4 v[104:107], v1, s[48:51], s68 offen offset:128 nt
  buffer_load_dwordx4 v[108:111], v1, s[48:51], s68 offen offset:256 nt
  s_add_u32 s68, s68, 380928
  s_nop 1
  v_mfma_f32_16x16x32_bf16 v[36:39], v[20:23], v[76:79], v[36:39]
  v_mfma_f32_16x16x32_bf16 v[40:43], v[20:23], v[80:83], v[40:43]
  v_mfma_f32_16x16x32_bf16 v[44:47], v[20:23], v[84:87], v[44:47]
  v_fma_f32 v14, v50, s71, v7
  v_exp_f32 v14, v14
  s_nop 0
  v_cvt_pk_bf16_f32 v13, v14, v14
  v_add_f32 v8, v8, v14
  v_and_b32 v20, v13, v2
  v_and_b32 v21, v13, v3
  v_and_b32 v22, v13, v4
  v_and_b32 v23, v13, v5
  s_waitcnt vmcnt(3)
  buffer_load_dwordx4 v[64:67], v1, s[48:51], s68 offen offset:0 nt
  buffer_load_dwordx4 v[68:71], v1, s[48:51], s68 offen offset:128 nt
  buffer_load_dwordx4 v[72:75], v1, s[48:51], s68 offen offset:256 nt
  s_add_u32 s68, s68, 12288
  s_nop 1
  v_mfma_f32_16x16x32_bf16 v[36:39], v[20:23], v[88:91], v[36:39]
  v_mfma_f32_16x16x32_bf16 v[40:43], v[20:23], v[92:95], v[40:43]
  v_mfma_f32_16x16x32_bf16 v[44:47], v[20:23], v[96:99], v[44:47]
  v_fma_f32 v14, v51, s71, v7
  v_exp_f32 v14, v14
  s_nop 0
  v_cvt_pk_bf16_f32 v13, v14, v14
  v_add_f32 v8, v8, v14
  v_and_b32 v20, v13, v2
  v_and_b32 v21, v13, v3
  v_and_b32 v22, v13, v4
  v_and_b32 v23, v13, v5
  s_waitcnt vmcnt(3)
  buffer_load_dwordx4 v[76:79], v1, s[48:51], s68 offen offset:0 nt
  buffer_load_dwordx4 v[80:83], v1, s[48:51], s68 offen offset:128 nt
  buffer_load_dwordx4 v[84:87], v1, s[48:51], s68 offen offset:256 nt
  s_add_u32 s68, s68, 380928
  s_nop 1
  v_mfma_f32_16x16x32_bf16 v[36:39], v[20:23], v[100:103], v[36:39]
  v_mfma_f32_16x16x32_bf16 v[40:43], v[20:23], v[104:107], v[40:43]
  v_mfma_f32_16x16x32_bf16 v[44:47], v[20:23], v[108:111], v[44:47]
  v_fma_f32 v14, v52, s71, v7
  v_exp_f32 v14, v14
  s_nop 0
  v_cvt_pk_bf16_f32 v13, v14, v14
  v_add_f32 v8, v8, v14
  v_and_b32 v20, v13, v2
  v_and_b32 v21, v13, v3
  v_and_b32 v22, v13, v4
  v_and_b32 v23, v13, v5
  s_waitcnt vmcnt(3)
  buffer_load_dwordx4 v[88:91], v1, s[48:51], s68 offen offset:0 nt
  buffer_load_dwordx4 v[92:95], v1, s[48:51], s68 offen offset:128 nt
  buffer_load_dwordx4 v[96:99], v1, s[48:51], s68 offen offset:256 nt
  s_add_u32 s68, s68, 12288
  s_nop 1
  v_mfma_f32_16x16x32_bf16 v[36:39], v[20:23], v[64:67], v[36:39]
  v_mfma_f32_16x16x32_bf16 v[40:43], v[20:23], v[68:71], v[40:43]
  v_mfma_f32_16x16x32_bf16 v[44:47], v[20:23], v[72:75], v[44:47]
  v_fma_f32 v14, v53, s71, v7
  v_exp_f32 v14, v14
  s_nop 0
  v_cvt_pk_bf16_f32 v13, v14, v14
  v_add_f32 v8, v8, v14
  v_and_b32 v20, v13, v2
  v_and_b32 v21, v13, v3
  v_and_b32 v22, v13, v4
  v_and_b32 v23, v13, v5
  s_waitcnt vmcnt(3)
  buffer_load_dwordx4 v[100:103], v1, s[48:51], s68 offen offset:0 nt
  buffer_load_dwordx4 v[104:107], v1, s[48:51], s68 offen offset:128 nt
  buffer_load_dwordx4 v[108:111], v1, s[48:51], s68 offen offset:256 nt
  s_add_u32 s68, s68, 380928
  s_nop 1
  v_mfma_f32_16x16x32_bf16 v[36:39], v[20:23], v[76:79], v[36:39]
  v_mfma_f32_16x16x32_bf16 v[40:43], v[20:23], v[80:83], v[40:43]
  v_mfma_f32_16x16x32_bf16 v[44:47], v[20:23], v[84:87], v[44:47]
  v_fma_f32 v14, v54, s71, v7
  v_exp_f32 v14, v14
  s_nop 0
  v_cvt_pk_bf16_f32 v13, v14, v14
  v_add_f32 v8, v8, v14
  v_and_b32 v20, v13, v2
  v_and_b32 v21, v13, v3
  v_and_b32 v22, v13, v4
  v_and_b32 v23, v13, v5
  s_waitcnt vmcnt(3)
  buffer_load_dwordx4 v[64:67], v1, s[48:51], s68 offen offset:0 nt
  buffer_load_dwordx4 v[68:71], v1, s[48:51], s68 offen offset:128 nt
  buffer_load_dwordx4 v[72:75], v1, s[48:51], s68 offen offset:256 nt
  s_add_u32 s68, s68, 12288
  s_nop 1
  v_mfma_f32_16x16x32_bf16 v[36:39], v[20:23], v[88:91], v[36:39]
  v_mfma_f32_16x16x32_bf16 v[40:43], v[20:23], v[92:95], v[40:43]
  v_mfma_f32_16x16x32_bf16 v[44:47], v[20:23], v[96:99], v[44:47]
  v_fma_f32 v14, v55, s71, v7
  v_exp_f32 v14, v14
  s_nop 0
  v_cvt_pk_bf16_f32 v13, v14, v14
  v_add_f32 v8, v8, v14
  v_and_b32 v20, v13, v2
  v_and_b32 v21, v13, v3
  v_and_b32 v22, v13, v4
  v_and_b32 v23, v13, v5
  s_waitcnt vmcnt(3)
  buffer_load_dwordx4 v[76:79], v1, s[48:51], s68 offen offset:0 nt
  buffer_load_dwordx4 v[80:83], v1, s[48:51], s68 offen offset:128 nt
  buffer_load_dwordx4 v[84:87], v1, s[48:51], s68 offen offset:256 nt
  s_add_u32 s68, s68, 380928
  s_nop 1
  v_mfma_f32_16x16x32_bf16 v[36:39], v[20:23], v[100:103], v[36:39]
  v_mfma_f32_16x16x32_bf16 v[40:43], v[20:23], v[104:107], v[40:43]
  v_mfma_f32_16x16x32_bf16 v[44:47], v[20:23], v[108:111], v[44:47]
  v_fma_f32 v14, v56, s71, v7
  v_exp_f32 v14, v14
  s_nop 0
  v_cvt_pk_bf16_f32 v13, v14, v14
  v_add_f32 v8, v8, v14
  v_and_b32 v20, v13, v2
  v_and_b32 v21, v13, v3
  v_and_b32 v22, v13, v4
  v_and_b32 v23, v13, v5
  s_waitcnt vmcnt(3)
  buffer_load_dwordx4 v[88:91], v1, s[48:51], s68 offen offset:0 nt
  buffer_load_dwordx4 v[92:95], v1, s[48:51], s68 offen offset:128 nt
  buffer_load_dwordx4 v[96:99], v1, s[48:51], s68 offen offset:256 nt
  s_add_u32 s68, s68, 12288
  s_nop 1
  v_mfma_f32_16x16x32_bf16 v[36:39], v[20:23], v[64:67], v[36:39]
  v_mfma_f32_16x16x32_bf16 v[40:43], v[20:23], v[68:71], v[40:43]
  v_mfma_f32_16x16x32_bf16 v[44:47], v[20:23], v[72:75], v[44:47]
  v_fma_f32 v14, v57, s71, v7
  v_exp_f32 v14, v14
  s_nop 0
  v_cvt_pk_bf16_f32 v13, v14, v14
  v_add_f32 v8, v8, v14
  v_and_b32 v20, v13, v2
  v_and_b32 v21, v13, v3
  v_and_b32 v22, v13, v4
  v_and_b32 v23, v13, v5
  s_waitcnt vmcnt(3)
  buffer_load_dwordx4 v[100:103], v1, s[48:51], s68 offen offset:0 nt
  buffer_load_dwordx4 v[104:107], v1, s[48:51], s68 offen offset:128 nt
  buffer_load_dwordx4 v[108:111], v1, s[48:51], s68 offen offset:256 nt
  s_add_u32 s68, s68, 380928
  s_nop 1
  v_mfma_f32_16x16x32_bf16 v[36:39], v[20:23], v[76:79], v[36:39]
  v_mfma_f32_16x16x32_bf16 v[40:43], v[20:23], v[80:83], v[40:43]
  v_mfma_f32_16x16x32_bf16 v[44:47], v[20:23], v[84:87], v[44:47]
  v_fma_f32 v14, v58, s71, v7
  v_exp_f32 v14, v14
  s_nop 0
  v_cvt_pk_bf16_f32 v13, v14, v14
  v_add_f32 v8, v8, v14
  v_and_b32 v20, v13, v2
  v_and_b32 v21, v13, v3
  v_and_b32 v22, v13, v4
  v_and_b32 v23, v13, v5
  s_waitcnt vmcnt(3)
  buffer_load_dwordx4 v[64:67], v1, s[48:51], s68 offen offset:0 nt
  buffer_load_dwordx4 v[68:71], v1, s[48:51], s68 offen offset:128 nt
  buffer_load_dwordx4 v[72:75], v1, s[48:51], s68 offen offset:256 nt
  s_add_u32 s68, s68, 12288
  s_nop 1
  v_mfma_f32_16x16x32_bf16 v[36:39], v[20:23], v[88:91], v[36:39]
  v_mfma_f32_16x16x32_bf16 v[40:43], v[20:23], v[92:95], v[40:43]
  v_mfma_f32_16x16x32_bf16 v[44:47], v[20:23], v[96:99], v[44:47]
  v_fma_f32 v14, v59, s71, v7
  v_exp_f32 v14, v14
  s_nop 0
  v_cvt_pk_bf16_f32 v13, v14, v14
  v_add_f32 v8, v8, v14
  v_and_b32 v20, v13, v2
  v_and_b32 v21, v13, v3
  v_and_b32 v22, v13, v4
  v_and_b32 v23, v13, v5
  s_waitcnt vmcnt(3)
  buffer_load_dwordx4 v[76:79], v1, s[48:51], s68 offen offset:0 nt
  buffer_load_dwordx4 v[80:83], v1, s[48:51], s68 offen offset:128 nt
  buffer_load_dwordx4 v[84:87], v1, s[48:51], s68 offen offset:256 nt
  s_add_u32 s68, s68, 380928
  s_nop 1
  v_mfma_f32_16x16x32_bf16 v[36:39], v[20:23], v[100:103], v[36:39]
  v_mfma_f32_16x16x32_bf16 v[40:43], v[20:23], v[104:107], v[40:43]
  v_mfma_f32_16x16x32_bf16 v[44:47], v[20:23], v[108:111], v[44:47]
  v_fma_f32 v14, v60, s71, v7
  v_exp_f32 v14, v14
  s_nop 0
  v_cvt_pk_bf16_f32 v13, v14, v14
  v_add_f32 v8, v8, v14
  v_and_b32 v20, v13, v2
  v_and_b32 v21, v13, v3
  v_and_b32 v22, v13, v4
  v_and_b32 v23, v13, v5
  s_waitcnt vmcnt(3)
  buffer_load_dwordx4 v[88:91], v1, s[48:51], s68 offen offset:0 nt
  buffer_load_dwordx4 v[92:95], v1, s[48:51], s68 offen offset:128 nt
  buffer_load_dwordx4 v[96:99], v1, s[48:51], s68 offen offset:256 nt
  s_add_u32 s68, s68, 12288
  s_nop 1
  v_mfma_f32_16x16x32_bf16 v[36:39], v[20:23], v[64:67], v[36:39]
  v_mfma_f32_16x16x32_bf16 v[40:43], v[20:23], v[68:71], v[40:43]
  v_mfma_f32_16x16x32_bf16 v[44:47], v[20:23], v[72:75], v[44:47]
  v_fma_f32 v14, v61, s71, v7
  v_exp_f32 v14, v14
  s_nop 0
  v_cvt_pk_bf16_f32 v13, v14, v14
  v_add_f32 v8, v8, v14
  v_and_b32 v20, v13, v2
  v_and_b32 v21, v13, v3
  v_and_b32 v22, v13, v4
  v_and_b32 v23, v13, v5
  s_waitcnt vmcnt(3)
  buffer_load_dwordx4 v[100:103], v1, s[48:51], s68 offen offset:0 nt
  buffer_load_dwordx4 v[104:107], v1, s[48:51], s68 offen offset:128 nt
  buffer_load_dwordx4 v[108:111], v1, s[48:51], s68 offen offset:256 nt
  s_add_u32 s68, s68, 47566848
  s_nop 1
  v_mfma_f32_16x16x32_bf16 v[36:39], v[20:23], v[76:79], v[36:39]
  v_mfma_f32_16x16x32_bf16 v[40:43], v[20:23], v[80:83], v[40:43]
  v_mfma_f32_16x16x32_bf16 v[44:47], v[20:23], v[84:87], v[44:47]
  v_fma_f32 v14, v62, s71, v7
  v_exp_f32 v14, v14
  s_nop 0
  v_cvt_pk_bf16_f32 v13, v14, v14
  v_add_f32 v8, v8, v14
  v_and_b32 v20, v13, v2
  v_and_b32 v21, v13, v3
  v_and_b32 v22, v13, v4
  v_and_b32 v23, v13, v5
  s_waitcnt vmcnt(3)
  buffer_load_dwordx4 v[64:67], v1, s[48:51], s68 offen offset:0 nt
  buffer_load_dwordx4 v[68:71], v1, s[48:51], s68 offen offset:128 nt
  buffer_load_dwordx4 v[72:75], v1, s[48:51], s68 offen offset:256 nt
  s_add_u32 s68, s68, 12288
  s_nop 1
  v_mfma_f32_16x16x32_bf16 v[36:39], v[20:23], v[88:91], v[36:39]
  v_mfma_f32_16x16x32_bf16 v[40:43], v[20:23], v[92:95], v[40:43]
  v_mfma_f32_16x16x32_bf16 v[44:47], v[20:23], v[96:99], v[44:47]
  v_fma_f32 v14, v63, s71, v7
  v_exp_f32 v14, v14
  s_nop 0
  v_cvt_pk_bf16_f32 v13, v14, v14
  v_add_f32 v8, v8, v14
  v_and_b32 v20, v13, v2
  v_and_b32 v21, v13, v3
  v_and_b32 v22, v13, v4
  v_and_b32 v23, v13, v5
  s_waitcnt vmcnt(3)
  buffer_load_dwordx4 v[76:79], v1, s[48:51], s68 offen offset:0 nt
  buffer_load_dwordx4 v[80:83], v1, s[48:51], s68 offen offset:128 nt
  buffer_load_dwordx4 v[84:87], v1, s[48:51], s68 offen offset:256 nt
  s_add_u32 s68, s68, 380928
  s_nop 1
  v_mfma_f32_16x16x32_bf16 v[36:39], v[20:23], v[100:103], v[36:39]
  v_mfma_f32_16x16x32_bf16 v[40:43], v[20:23], v[104:107], v[40:43]
  v_mfma_f32_16x16x32_bf16 v[44:47], v[20:23], v[108:111], v[44:47]
  v_add_f32_dpp v12, v8, v8 row_ror:8 row_mask:0xf bank_mask:0xf
  s_mov_b32 exec_lo, 0x00010001
  s_mov_b32 exec_hi, 0x00010001
  ds_write_b32 v18, v12 offset:6144
  ds_write_b32 v17, v7 offset:6208
  s_mov_b32 exec_lo, 0x00ff00ff
  s_mov_b32 exec_hi, 0xff00ff00
  v_mov_b32 v14, 1
  v_and_b32 v9, -16, v17
  s_nop 1
  ds_write_b128 v19, v[36:39] offset:0
  ds_write_b128 v19, v[40:43] offset:256
  ds_write_b128 v19, v[44:47] offset:512
  s_mov_b64 exec, 1
  ds_add_u32 v9, v14 offset:6224
  s_mov_b64 exec, -1
  v_add_u32 v18, 6272, v18
  v_add_u32 v19, 6272, v19
  v_add_u32 v17, 6272, v17
  ds_read_b128 v[48:51], v0 offset:0
  ds_read_b128 v[52:55], v0 offset:16
  ds_read_b128 v[56:59], v0 offset:32
  ds_read_b128 v[60:63], v0 offset:48
  ds_read_b32 v7, v0 offset:64
  v_add_u32 v0, 640, v0
  s_waitcnt lgkmcnt(0)
  v_fma_f32 v14, v48, s71, v7
  v_exp_f32 v14, v14
  s_nop 0
  v_cvt_pk_bf16_f32 v13, v14, v14
  v_mov_b32 v8, v14
  v_and_b32 v20, v13, v2
  v_and_b32 v21, v13, v3
  v_and_b32 v22, v13, v4
  v_and_b32 v23, v13, v5
  s_waitcnt vmcnt(3)
  buffer_load_dwordx4 v[88:91], v1, s[48:51], s68 offen offset:0 nt
  buffer_load_dwordx4 v[92:95], v1, s[48:51], s68 offen offset:128 nt
  buffer_load_dwordx4 v[96:99], v1, s[48:51], s68 offen offset:256 nt
  s_add_u32 s68, s68, 12288
  s_nop 1
  v_mfma_f32_16x16x32_bf16 v[36:39], v[20:23], v[64:67], 0
  v_mfma_f32_16x16x32_bf16 v[40:43], v[20:23], v[68:71], 0
  v_mfma_f32_16x16x32_bf16 v[44:47], v[20:23], v[72:75], 0
  s_sub_u32 s69, s69, 1
  s_cmp_lg_u32 s69, 0
  s_cbranch_scc1 L_loop2
  v_fma_f32 v14, v49, s71, v7
  v_exp_f32 v14, v14
  s_nop 0
  v_cvt_pk_bf16_f32 v13, v14, v14
  v_add_f32 v8, v8, v14
  v_and_b32 v20, v13, v2
  v_and_b32 v21, v13, v3
  v_and_b32 v22, v13, v4
  v_and_b32 v23, v13, v5
  s_waitcnt vmcnt(3)
  buffer_load_dwordx4 v[100:103], v1, s[48:51], s68 offen offset:0 nt
  buffer_load_dwordx4 v[104:107], v1, s[48:51], s68 offen offset:128 nt
  buffer_load_dwordx4 v[108:111], v1, s[48:51], s68 offen offset:256 nt
  s_add_u32 s68, s68, 380928
  s_nop 1
  v_mfma_f32_16x16x32_bf16 v[36:39], v[20:23], v[76:79], v[36:39]
  v_mfma_f32_16x16x32_bf16 v[40:43], v[20:23], v[80:83], v[40:43]
  v_mfma_f32_16x16x32_bf16 v[44:47], v[20:23], v[84:87], v[44:47]
  v_fma_f32 v14, v50, s71, v7
  v_exp_f32 v14, v14
  s_nop 0
  v_cvt_pk_bf16_f32 v13, v14, v14
  v_add_f32 v8, v8, v14
  v_and_b32 v20, v13, v2
  v_and_b32 v21, v13, v3
  v_and_b32 v22, v13, v4
  v_and_b32 v23, v13, v5
  s_waitcnt vmcnt(3)
  buffer_load_dwordx4 v[64:67], v1, s[48:51], s68 offen offset:0 nt
  buffer_load_dwordx4 v[68:71], v1, s[48:51], s68 offen offset:128 nt
  buffer_load_dwordx4 v[72:75], v1, s[48:51], s68 offen offset:256 nt
  s_add_u32 s68, s68, 12288
  s_nop 1
  v_mfma_f32_16x16x32_bf16 v[36:39], v[20:23], v[88:91], v[36:39]
  v_mfma_f32_16x16x32_bf16 v[40:43], v[20:23], v[92:95], v[40:43]
  v_mfma_f32_16x16x32_bf16 v[44:47], v[20:23], v[96:99], v[44:47]
  v_fma_f32 v14, v51, s71, v7
  v_exp_f32 v14, v14
  s_nop 0
  v_cvt_pk_bf16_f32 v13, v14, v14
  v_add_f32 v8, v8, v14
  v_and_b32 v20, v13, v2
  v_and_b32 v21, v13, v3
  v_and_b32 v22, v13, v4
  v_and_b32 v23, v13, v5
  s_waitcnt vmcnt(3)
  buffer_load_dwordx4 v[76:79], v1, s[48:51], s68 offen offset:0 nt
  buffer_load_dwordx4 v[80:83], v1, s[48:51], s68 offen offset:128 nt
  buffer_load_dwordx4 v[84:87], v1, s[48:51], s68 offen offset:256 nt
  s_add_u32 s68, s68, 380928
  s_nop 1
  v_mfma_f32_16x16x32_bf16 v[36:39], v[20:23], v[100:103], v[36:39]
  v_mfma_f32_16x16x32_bf16 v[40:43], v[20:23], v[104:107], v[40:43]
  v_mfma_f32_16x16x32_bf16 v[44:47], v[20:23], v[108:111], v[44:47]
  v_fma_f32 v14, v52, s71, v7
  v_exp_f32 v14, v14
  s_nop 0
  v_cvt_pk_bf16_f32 v13, v14, v14
  v_add_f32 v8, v8, v14
  v_and_b32 v20, v13, v2
  v_and_b32 v21, v13, v3
  v_and_b32 v22, v13, v4
  v_and_b32 v23, v13, v5
  s_waitcnt vmcnt(3)
  buffer_load_dwordx4 v[88:91], v1, s[48:51], s68 offen offset:0 nt
  buffer_load_dwordx4 v[92:95], v1, s[48:51], s68 offen offset:128 nt
  buffer_load_dwordx4 v[96:99], v1, s[48:51], s68 offen offset:256 nt
  s_add_u32 s68, s68, 12288
  s_nop 1
  v_mfma_f32_16x16x32_bf16 v[36:39], v[20:23], v[64:67], v[36:39]
  v_mfma_f32_16x16x32_bf16 v[40:43], v[20:23], v[68:71], v[40:43]
  v_mfma_f32_16x16x32_bf16 v[44:47], v[20:23], v[72:75], v[44:47]
  v_fma_f32 v14, v53, s71, v7
  v_exp_f32 v14, v14
  s_nop 0
  v_cvt_pk_bf16_f32 v13, v14, v14
  v_add_f32 v8, v8, v14
  v_and_b32 v20, v13, v2
  v_and_b32 v21, v13, v3
  v_and_b32 v22, v13, v4
  v_and_b32 v23, v13, v5
  s_waitcnt vmcnt(3)
  buffer_load_dwordx4 v[100:103], v1, s[48:51], s68 offen offset:0 nt
  buffer_load_dwordx4 v[104:107], v1, s[48:51], s68 offen offset:128 nt
  buffer_load_dwordx4 v[108:111], v1, s[48:51], s68 offen offset:256 nt
  s_add_u32 s68, s68, 380928
  s_nop 1
  v_mfma_f32_16x16x32_bf16 v[36:39], v[20:23], v[76:79], v[36:39]
  v_mfma_f32_16x16x32_bf16 v[40:43], v[20:23], v[80:83], v[40:43]
  v_mfma_f32_16x16x32_bf16 v[44:47], v[20:23], v[84:87], v[44:47]
  v_fma_f32 v14, v54, s71, v7
  v_exp_f32 v14, v14
  s_nop 0
  v_cvt_pk_bf16_f32 v13, v14, v14
  v_add_f32 v8, v8, v14
  v_and_b32 v20, v13, v2
  v_and_b32 v21, v13, v3
  v_and_b32 v22, v13, v4
  v_and_b32 v23, v13, v5
  s_waitcnt vmcnt(3)
  buffer_load_dwordx4 v[64:67], v1, s[48:51], s68 offen offset:0 nt
  buffer_load_dwordx4 v[68:71], v1, s[48:51], s68 offen offset:128 nt
  buffer_load_dwordx4 v[72:75], v1, s[48:51], s68 offen offset:256 nt
  s_add_u32 s68, s68, 12288
  s_nop 1
  v_mfma_f32_16x16x32_bf16 v[36:39], v[20:23], v[88:91], v[36:39]
  v_mfma_f32_16x16x32_bf16 v[40:43], v[20:23], v[92:95], v[40:43]
  v_mfma_f32_16x16x32_bf16 v[44:47], v[20:23], v[96:99], v[44:47]
  v_fma_f32 v14, v55, s71, v7
  v_exp_f32 v14, v14
  s_nop 0
  v_cvt_pk_bf16_f32 v13, v14, v14
  v_add_f32 v8, v8, v14
  v_and_b32 v20, v13, v2
  v_and_b32 v21, v13, v3
  v_and_b32 v22, v13, v4
  v_and_b32 v23, v13, v5
  s_waitcnt vmcnt(3)
  buffer_load_dwordx4 v[76:79], v1, s[48:51], s68 offen offset:0 nt
  buffer_load_dwordx4 v[80:83], v1, s[48:51], s68 offen offset:128 nt
  buffer_load_dwordx4 v[84:87], v1, s[48:51], s68 offen offset:256 nt
  s_add_u32 s68, s68, 380928
  s_nop 1
  v_mfma_f32_16x16x32_bf16 v[36:39], v[20:23], v[100:103], v[36:39]
  v_mfma_f32_16x16x32_bf16 v[40:43], v[20:23], v[104:107], v[40:43]
  v_mfma_f32_16x16x32_bf16 v[44:47], v[20:23], v[108:111], v[44:47]
  v_fma_f32 v14, v56, s71, v7
  v_exp_f32 v14, v14
  s_nop 0
  v_cvt_pk_bf16_f32 v13, v14, v14
  v_add_f32 v8, v8, v14
  v_and_b32 v20, v13, v2
  v_and_b32 v21, v13, v3
  v_and_b32 v22, v13, v4
  v_and_b32 v23, v13, v5
  s_waitcnt vmcnt(3)
  buffer_load_dwordx4 v[88:91], v1, s[48:51], s68 offen offset:0 nt
  buffer_load_dwordx4 v[92:95], v1, s[48:51], s68 offen offset:128 nt
  buffer_load_dwordx4 v[96:99], v1, s[48:51], s68 offen offset:256 nt
  s_add_u32 s68, s68, 12288
  s_nop 1
  v_mfma_f32_16x16x32_bf16 v[36:39], v[20:23], v[64:67], v[36:39]
  v_mfma_f32_16x16x32_bf16 v[40:43], v[20:23], v[68:71], v[40:43]
  v_mfma_f32_16x16x32_bf16 v[44:47], v[20:23], v[72:75], v[44:47]
  v_fma_f32 v14, v57, s71, v7
  v_exp_f32 v14, v14
  s_nop 0
  v_cvt_pk_bf16_f32 v13, v14, v14
  v_add_f32 v8, v8, v14
  v_and_b32 v20, v13, v2
  v_and_b32 v21, v13, v3
  v_and_b32 v22, v13, v4
  v_and_b32 v23, v13, v5
  s_waitcnt vmcnt(3)
  buffer_load_dwordx4 v[100:103], v1, s[48:51], s68 offen offset:0 nt
  buffer_load_dwordx4 v[104:107], v1, s[48:51], s68 offen offset:128 nt
  buffer_load_dwordx4 v[108:111], v1, s[48:51], s68 offen offset:256 nt
  s_add_u32 s68, s68, 380928
  s_nop 1
  v_mfma_f32_16x16x32_bf16 v[36:39], v[20:23], v[76:79], v[36:39]
  v_mfma_f32_16x16x32_bf16 v[40:43], v[20:23], v[80:83], v[40:43]
  v_mfma_f32_16x16x32_bf16 v[44:47], v[20:23], v[84:87], v[44:47]
  v_fma_f32 v14, v58, s71, v7
  v_exp_f32 v14, v14
  s_nop 0
  v_cvt_pk_bf16_f32 v13, v14, v14
  v_add_f32 v8, v8, v14
  v_and_b32 v20, v13, v2
  v_and_b32 v21, v13, v3
  v_and_b32 v22, v13, v4
  v_and_b32 v23, v13, v5
  s_waitcnt vmcnt(3)
  buffer_load_dwordx4 v[64:67], v1, s[48:51], s68 offen offset:0 nt
  buffer_load_dwordx4 v[68:71], v1, s[48:51], s68 offen offset:128 nt
  buffer_load_dwordx4 v[72:75], v1, s[48:51], s68 offen offset:256 nt
  s_add_u32 s68, s68, 12288
  s_nop 1
  v_mfma_f32_16x16x32_bf16 v[36:39], v[20:23], v[88:91], v[36:39]
  v_mfma_f32_16x16x32_bf16 v[40:43], v[20:23], v[92:95], v[40:43]
  v_mfma_f32_16x16x32_bf16 v[44:47], v[20:23], v[96:99], v[44:47]
  v_fma_f32 v14, v59, s71, v7
  v_exp_f32 v14, v14
  s_nop 0
  v_cvt_pk_bf16_f32 v13, v14, v14
  v_add_f32 v8, v8, v14
  v_and_b32 v20, v13, v2
  v_and_b32 v21, v13, v3
  v_and_b32 v22, v13, v4
  v_and_b32 v23, v13, v5
  s_waitcnt vmcnt(3)
  buffer_load_dwordx4 v[76:79], v1, s[48:51], s68 offen offset:0 nt
  buffer_load_dwordx4 v[80:83], v1, s[48:51], s68 offen offset:128 nt
  buffer_load_dwordx4 v[84:87], v1, s[48:51], s68 offen offset:256 nt
  s_add_u32 s68, s68, 380928
  s_nop 1
  v_mfma_f32_16x16x32_bf16 v[36:39], v[20:23], v[100:103], v[36:39]
  v_mfma_f32_16x16x32_bf16 v[40:43], v[20:23], v[104:107], v[40:43]
  v_mfma_f32_16x16x32_bf16 v[44:47], v[20:23], v[108:111], v[44:47]
  v_fma_f32 v14, v60, s71, v7
  v_exp_f32 v14, v14
  s_nop 0
  v_cvt_pk_bf16_f32 v13, v14, v14
  v_add_f32 v8, v8, v14
  v_and_b32 v20, v13, v2
  v_and_b32 v21, v13, v3
  v_and_b32 v22, v13, v4
  v_and_b32 v23, v13, v5
  s_waitcnt vmcnt(3)
  buffer_load_dwordx4 v[88:91], v1, s[48:51], s68 offen offset:0 nt
  buffer_load_dwordx4 v[92:95], v1, s[48:51], s68 offen offset:128 nt
  buffer_load_dwordx4 v[96:99], v1, s[48:51], s68 offen offset:256 nt
  s_add_u32 s68, s68, 12288
  s_nop 1
  v_mfma_f32_16x16x32_bf16 v[36:39], v[20:23], v[64:67], v[36:39]
  v_mfma_f32_16x16x32_bf16 v[40:43], v[20:23], v[68:71], v[40:43]
  v_mfma_f32_16x16x32_bf16 v[44:47], v[20:23], v[72:75], v[44:47]
  v_fma_f32 v14, v61, s71, v7
  v_exp_f32 v14, v14
  s_nop 0
  v_cvt_pk_bf16_f32 v13, v14, v14
  v_add_f32 v8, v8, v14
  v_and_b32 v20, v13, v2
  v_and_b32 v21, v13, v3
  v_and_b32 v22, v13, v4
  v_and_b32 v23, v13, v5
  s_waitcnt vmcnt(3)
  buffer_load_dwordx4 v[100:103], v1, s[48:51], s68 offen offset:0 nt
  buffer_load_dwordx4 v[104:107], v1, s[48:51], s68 offen offset:128 nt
  buffer_load_dwordx4 v[108:111], v1, s[48:51], s68 offen offset:256 nt
  s_mov_b32 s68, s10
  s_nop 1
  v_mfma_f32_16x16x32_bf16 v[36:39], v[20:23], v[76:79], v[36:39]
  v_mfma_f32_16x16x32_bf16 v[40:43], v[20:23], v[80:83], v[40:43]
  v_mfma_f32_16x16x32_bf16 v[44:47], v[20:23], v[84:87], v[44:47]
  v_fma_f32 v14, v62, s71, v7
  v_exp_f32 v14, v14
  s_nop 0
  v_cvt_pk_bf16_f32 v13, v14, v14
  v_add_f32 v8, v8, v14
  v_and_b32 v20, v13, v2
  v_and_b32 v21, v13, v3
  v_and_b32 v22, v13, v4
  v_and_b32 v23, v13, v5
  s_waitcnt vmcnt(3)
  v_mov_b32 v112, 4
  s_mov_b64 exec, 1
  ds_max_u32 v15, v112 offset:12
  s_mov_b64 exec, -1
  v_mov_b32 v112, 0
  buffer_load_dwordx4 v[64:67], v1, s[48:51], s68 offen offset:0 nt
  buffer_load_dwordx4 v[68:71], v1, s[48:51], s68 offen offset:128 nt
  buffer_load_dwordx4 v[72:75], v1, s[48:51], s68 offen offset:256 nt
  s_add_u32 s68, s68, 12288
  s_nop 1
  v_mfma_f32_16x16x32_bf16 v[36:39], v[20:23], v[88:91], v[36:39]
  v_mfma_f32_16x16x32_bf16 v[40:43], v[20:23], v[92:95], v[40:43]
  v_mfma_f32_16x16x32_bf16 v[44:47], v[20:23], v[96:99], v[44:47]
  v_fma_f32 v14, v63, s71, v7
  v_exp_f32 v14, v14
  s_nop 0
  v_cvt_pk_bf16_f32 v13, v14, v14
  v_add_f32 v8, v8, v14
  v_and_b32 v20, v13, v2
  v_and_b32 v21, v13, v3
  v_and_b32 v22, v13, v4
  v_and_b32 v23, v13, v5
  s_waitcnt vmcnt(3)
  buffer_load_dwordx4 v[76:79], v1, s[48:51], s68 offen offset:0 nt
  buffer_load_dwordx4 v[80:83], v1, s[48:51], s68 offen offset:128 nt
  buffer_load_dwordx4 v[84:87], v1, s[48:51], s68 offen offset:256 nt
  s_add_u32 s68, s68, 12288
  s_nop 1
  v_mfma_f32_16x16x32_bf16 v[36:39], v[20:23], v[100:103], v[36:39]
  v_mfma_f32_16x16x32_bf16 v[40:43], v[20:23], v[104:107], v[40:43]
  v_mfma_f32_16x16x32_bf16 v[44:47], v[20:23], v[108:111], v[44:47]
  v_add_f32_dpp v12, v8, v8 row_ror:8 row_mask:0xf bank_mask:0xf
  s_mov_b32 exec_lo, 0x00010001
  s_mov_b32 exec_hi, 0x00010001
  ds_write_b32 v18, v12 offset:6144
  ds_write_b32 v17, v7 offset:6208
  s_mov_b32 exec_lo, 0x00ff00ff
  s_mov_b32 exec_hi, 0xff00ff00
  v_mov_b32 v14, 1
  v_and_b32 v9, -16, v17
  s_nop 1
  ds_write_b128 v19, v[36:39] offset:0
  ds_write_b128 v19, v[40:43] offset:256
  ds_write_b128 v19, v[44:47] offset:512
  s_mov_b64 exec, 1
  ds_add_u32 v9, v14 offset:6224
  s_mov_b64 exec, -1
  v_add_u32 v18, 6272, v18
  v_add_u32 v19, 6272, v19
  v_add_u32 v17, 6272, v17
  ds_read_b128 v[48:51], v0 offset:0
  ds_read_b128 v[52:55], v0 offset:16
  ds_read_b128 v[56:59], v0 offset:32
  ds_read_b128 v[60:63], v0 offset:48
  ds_read_b32 v7, v0 offset:64
  v_add_u32 v0, 640, v0
  s_waitcnt lgkmcnt(0)
  v_fma_f32 v14, v48, s71, v7
  v_exp_f32 v14, v14
  s_nop 0
  v_cvt_pk_bf16_f32 v13, v14, v14
  v_mov_b32 v8, v14
  v_and_b32 v20, v13, v2
  v_and_b32 v21, v13, v3
  v_and_b32 v22, v13, v4
  v_and_b32 v23, v13, v5
  s_waitcnt vmcnt(3)
  buffer_load_dwordx4 v[88:91], v1, s[48:51], s68 offen offset:0 nt
  buffer_load_dwordx4 v[92:95], v1, s[48:51], s68 offen offset:128 nt
  buffer_load_dwordx4 v[96:99], v1, s[48:51], s68 offen offset:256 nt
  s_add_u32 s68, s68, 12288
  s_nop 1
  v_mfma_f32_16x16x32_bf16 v[36:39], v[20:23], v[64:67], 0
  v_mfma_f32_16x16x32_bf16 v[40:43], v[20:23], v[68:71], 0
  v_mfma_f32_16x16x32_bf16 v[44:47], v[20:23], v[72:75], 0
  v_fma_f32 v14, v49, s71, v7
  v_exp_f32 v14, v14
  s_nop 0
  v_cvt_pk_bf16_f32 v13, v14, v14
  v_add_f32 v8, v8, v14
  v_and_b32 v20, v13, v2
  v_and_b32 v21, v13, v3
  v_and_b32 v22, v13, v4
  v_and_b32 v23, v13, v5
  s_waitcnt vmcnt(3)
  buffer_load_dwordx4 v[100:103], v1, s[48:51], s68 offen offset:0 nt
  buffer_load_dwordx4 v[104:107], v1, s[48:51], s68 offen offset:128 nt
  buffer_load_dwordx4 v[108:111], v1, s[48:51], s68 offen offset:256 nt
  s_nop 1
  v_mfma_f32_16x16x32_bf16 v[36:39], v[20:23], v[76:79], v[36:39]
  v_mfma_f32_16x16x32_bf16 v[40:43], v[20:23], v[80:83], v[40:43]
  v_mfma_f32_16x16x32_bf16 v[44:47], v[20:23], v[84:87], v[44:47]
  v_fma_f32 v14, v50, s71, v7
  v_exp_f32 v14, v14
  s_nop 0
  v_cvt_pk_bf16_f32 v13, v14, v14
  v_add_f32 v8, v8, v14
  v_and_b32 v20, v13, v2
  v_and_b32 v21, v13, v3
  v_and_b32 v22, v13, v4
  v_and_b32 v23, v13, v5
  ds_read_b32 v113, v112 offset:3328
  s_waitcnt vmcnt(3)
  s_waitcnt lgkmcnt(0)
  v_readfirstlane_b32 s42, v113
  v_add_u32 v113, 8, v112
  s_cmp_eq_u32 s42, -1
  s_cbranch_scc1 L_tw_9
L_tb_10:
  s_cmp_ge_u32 s42, 192
  s_cbranch_scc1 L_drain_8
  s_mov_b64 exec, 1
  ds_max_u32 v15, v113 offset:12
  s_mov_b64 exec, -1
  v_add_u32 v112, 4, v112
  s_mul_i32 s43, s42, 12288
  s_add_u32 s68, s43, s11
  buffer_load_dwordx4 v[64:67], v1, s[44:47], s68 offen offset:0 nt
  buffer_load_dwordx4 v[68:71], v1, s[44:47], s68 offen offset:128 nt
  buffer_load_dwordx4 v[72:75], v1, s[44:47], s68 offen offset:256 nt
  s_nop 1
  v_mfma_f32_16x16x32_bf16 v[36:39], v[20:23], v[88:91], v[36:39]
  v_mfma_f32_16x16x32_bf16 v[40:43], v[20:23], v[92:95], v[40:43]
  v_mfma_f32_16x16x32_bf16 v[44:47], v[20:23], v[96:99], v[44:47]
  v_fma_f32 v14, v51, s71, v7
  v_exp_f32 v14, v14
  s_nop 0
  v_cvt_pk_bf16_f32 v13, v14, v14
  v_add_f32 v8, v8, v14
  v_and_b32 v20, v13, v2
  v_and_b32 v21, v13, v3
  v_and_b32 v22, v13, v4
  v_and_b32 v23, v13, v5
  s_waitcnt vmcnt(3)
  buffer_load_dwordx4 v[76:79], v1, s[48:51], s68 offen offset:0 nt
  buffer_load_dwordx4 v[80:83], v1, s[48:51], s68 offen offset:128 nt
  buffer_load_dwordx4 v[84:87], v1, s[48:51], s68 offen offset:256 nt
  s_nop 1
  v_mfma_f32_16x16x32_bf16 v[36:39], v[20:23], v[100:103], v[36:39]
  v_mfma_f32_16x16x32_bf16 v[40:43], v[20:23], v[104:107], v[40:43]
  v_mfma_f32_16x16x32_bf16 v[44:47], v[20:23], v[108:111], v[44:47]
  s_mov_b32 s69, 0
L_loopdyn:
  ds_read_b32 v113, v112 offset:3328
  s_waitcnt vmcnt(3)
  s_waitcnt lgkmcnt(0)
  v_readfirstlane_b32 s42, v113
  v_add_u32 v113, 8, v112
  s_cmp_eq_u32 s42, -1
  s_cbranch_scc1 L_tw_12
L_tb_13:
  s_cmp_ge_u32 s42, 192
  s_cbranch_scc1 L_drain_11
  s_mov_b64 exec, 1
  ds_max_u32 v15, v113 offset:12
  s_mov_b64 exec, -1
  v_add_u32 v112, 4, v112
  s_mul_i32 s43, s42, 12288
  s_add_u32 s68, s43, s11
  buffer_load_dwordx4 v[88:91], v1, s[44:47], s68 offen offset:0 nt
  buffer_load_dwordx4 v[92:95], v1, s[44:47], s68 offen offset:128 nt
  buffer_load_dwordx4 v[96:99], v1, s[44:47], s68 offen offset:256 nt
  v_dot2_f32_bf16 v9, v64, v24, 0
  v_dot2_f32_bf16 v10, v68, v28, 0
  v_dot2_f32_bf16 v11, v72, v32, 0
  v_dot2_f32_bf16 v9, v65, v25, v9
  v_dot2_f32_bf16 v10, v69, v29, v10
  v_dot2_f32_bf16 v11, v73, v33, v11
  v_dot2_f32_bf16 v9, v66, v26, v9
  v_dot2_f32_bf16 v10, v70, v30, v10
  v_dot2_f32_bf16 v11, v74, v34, v11
  v_dot2_f32_bf16 v9, v67, v27, v9
  v_dot2_f32_bf16 v10, v71, v31, v10
  v_dot2_f32_bf16 v11, v75, v35, v11
  s_nop 1
  v_add_f32 v12, v9, v10
  v_add_f32 v12, v12, v11
  s_nop 1
  v_add_f32_dpp v12, v12, v12 quad_perm:[1,0,3,2] row_mask:0xf bank_mask:0xf
  s_nop 1
  v_add_f32_dpp v12, v12, v12 quad_perm:[2,3,0,1] row_mask:0xf bank_mask:0xf
  s_nop 1
  v_add_f32_dpp v12, v12, v12 row_half_mirror row_mask:0xf bank_mask:0xf
  v_cvt_pk_bf16_f32 v12, v12, v12
  v_lshlrev_b32 v12, 16, v12
  v_mul_f32 v12, s72, v12
  v_cvt_pk_bf16_f32 v12, v12, v12
  v_lshlrev_b32 v12, 16, v12
  v_cmp_gt_f32 vcc, v12, v6
  s_cbranch_vccnz L_rare_14
L_back_15:
  v_fma_f32 v14, v12, s71, v7
  v_exp_f32 v14, v14
  s_nop 0
  v_cvt_pk_bf16_f32 v13, v14, v14
  v_add_f32 v8, v8, v14
  v_and_b32 v20, v13, v2
  v_and_b32 v21, v13, v3
  v_and_b32 v22, v13, v4
  v_and_b32 v23, v13, v5
  s_waitcnt vmcnt(3)
  buffer_load_dwordx4 v[100:103], v1, s[48:51], s68 offen offset:0 nt
  buffer_load_dwordx4 v[104:107], v1, s[48:51], s68 offen offset:128 nt
  buffer_load_dwordx4 v[108:111], v1, s[48:51], s68 offen offset:256 nt
  s_nop 1
  v_mfma_f32_16x16x32_bf16 v[36:39], v[20:23], v[76:79], v[36:39]
  v_mfma_f32_16x16x32_bf16 v[40:43], v[20:23], v[80:83], v[40:43]
  v_mfma_f32_16x16x32_bf16 v[44:47], v[20:23], v[84:87], v[44:47]
  ds_read_b32 v113, v112 offset:3328
  s_waitcnt vmcnt(3)
  s_waitcnt lgkmcnt(0)
  v_readfirstlane_b32 s42, v113
  v_add_u32 v113, 8, v112
  s_cmp_eq_u32 s42, -1
  s_cbranch_scc1 L_tw_17
L_tb_18:
  s_cmp_ge_u32 s42, 192
  s_cbranch_scc1 L_drain_16
  s_mov_b64 exec, 1
  ds_max_u32 v15, v113 offset:12
  s_mov_b64 exec, -1
  v_add_u32 v112, 4, v112
  s_mul_i32 s43, s42, 12288
  s_add_u32 s68, s43, s11
  buffer_load_dwordx4 v[64:67], v1, s[44:47], s68 offen offset:0 nt
  buffer_load_dwordx4 v[68:71], v1, s[44:47], s68 offen offset:128 nt
  buffer_load_dwordx4 v[72:75], v1, s[44:47], s68 offen offset:256 nt
  v_dot2_f32_bf16 v9, v88, v24, 0
  v_dot2_f32_bf16 v10, v92, v28, 0
  v_dot2_f32_bf16 v11, v96, v32, 0
  v_dot2_f32_bf16 v9, v89, v25, v9
  v_dot2_f32_bf16 v10, v93, v29, v10
  v_dot2_f32_bf16 v11, v97, v33, v11
  v_dot2_f32_bf16 v9, v90, v26, v9
  v_dot2_f32_bf16 v10, v94, v30, v10
  v_dot2_f32_bf16 v11, v98, v34, v11
  v_dot2_f32_bf16 v9, v91, v27, v9
  v_dot2_f32_bf16 v10, v95, v31, v10
  v_dot2_f32_bf16 v11, v99, v35, v11
  s_nop 1
  v_add_f32 v12, v9, v10
  v_add_f32 v12, v12, v11
  s_nop 1
  v_add_f32_dpp v12, v12, v12 quad_perm:[1,0,3,2] row_mask:0xf bank_mask:0xf
  s_nop 1
  v_add_f32_dpp v12, v12, v12 quad_perm:[2,3,0,1] row_mask:0xf bank_mask:0xf
  s_nop 1
  v_add_f32_dpp v12, v12, v12 row_half_mirror row_mask:0xf bank_mask:0xf
  v_cvt_pk_bf16_f32 v12, v12, v12
  v_lshlrev_b32 v12, 16, v12
  v_mul_f32 v12, s72, v12
  v_cvt_pk_bf16_f32 v12, v12, v12
  v_lshlrev_b32 v12, 16, v12
  v_cmp_gt_f32 vcc, v12, v6
  s_cbranch_vccnz L_rare_19
L_back_20:
  v_fma_f32 v14, v12, s71, v7
  v_exp_f32 v14, v14
  s_nop 0
  v_cvt_pk_bf16_f32 v13, v14, v14
  v_add_f32 v8, v8, v14
  v_and_b32 v20, v13, v2
  v_and_b32 v21, v13, v3
  v_and_b32 v22, v13, v4
  v_and_b32 v23, v13, v5
  s_waitcnt vmcnt(3)
  buffer_load_dwordx4 v[76:79], v1, s[48:51], s68 offen offset:0 nt
  buffer_load_dwordx4 v[80:83], v1, s[48:51], s68 offen offset:128 nt
  buffer_load_dwordx4 v[84:87], v1, s[48:51], s68 offen offset:256 nt
  s_nop 1
  v_mfma_f32_16x16x32_bf16 v[36:39], v[20:23], v[100:103], v[36:39]
  v_mfma_f32_16x16x32_bf16 v[40:43], v[20:23], v[104:107], v[40:43]
  v_mfma_f32_16x16x32_bf16 v[44:47], v[20:23], v[108:111], v[44:47]
  s_add_u32 s69, s69, 1
  s_cmp_lt_u32 s69, 256
  s_cbranch_scc1 L_loopdyn
  s_waitcnt vmcnt(0) lgkmcnt(0)
  s_branch L_tail
L_drain_8:
  s_nop 1
  v_mfma_f32_16x16x32_bf16 v[36:39], v[20:23], v[88:91], v[36:39]
  v_mfma_f32_16x16x32_bf16 v[40:43], v[20:23], v[92:95], v[40:43]
  v_mfma_f32_16x16x32_bf16 v[44:47], v[20:23], v[96:99], v[44:47]
  v_fma_f32 v14, v51, s71, v7
  v_exp_f32 v14, v14
  s_nop 0
  v_cvt_pk_bf16_f32 v13, v14, v14
  v_add_f32 v8, v8, v14
  v_and_b32 v20, v13, v2
  v_and_b32 v21, v13, v3
  v_and_b32 v22, v13, v4
  v_and_b32 v23, v13, v5
  s_waitcnt vmcnt(0)
  s_nop 1
  v_mfma_f32_16x16x32_bf16 v[36:39], v[20:23], v[100:103], v[36:39]
  v_mfma_f32_16x16x32_bf16 v[40:43], v[20:23], v[104:107], v[40:43]
  v_mfma_f32_16x16x32_bf16 v[44:47], v[20:23], v[108:111], v[44:47]
  s_branch L_tail
L_drain_11:
  v_dot2_f32_bf16 v9, v64, v24, 0
  v_dot2_f32_bf16 v10, v68, v28, 0
  v_dot2_f32_bf16 v11, v72, v32, 0
  v_dot2_f32_bf16 v9, v65, v25, v9
  v_dot2_f32_bf16 v10, v69, v29, v10
  v_dot2_f32_bf16 v11, v73, v33, v11
  v_dot2_f32_bf16 v9, v66, v26, v9
  v_dot2_f32_bf16 v10, v70, v30, v10
  v_dot2_f32_bf16 v11, v74, v34, v11
  v_dot2_f32_bf16 v9, v67, v27, v9
  v_dot2_f32_bf16 v10, v71, v31, v10
  v_dot2_f32_bf16 v11, v75, v35, v11
  s_nop 1
  v_add_f32 v12, v9, v10
  v_add_f32 v12, v12, v11
  s_nop 1
  v_add_f32_dpp v12, v12, v12 quad_perm:[1,0,3,2] row_mask:0xf bank_mask:0xf
  s_nop 1
  v_add_f32_dpp v12, v12, v12 quad_perm:[2,3,0,1] row_mask:0xf bank_mask:0xf
  s_nop 1
  v_add_f32_dpp v12, v12, v12 row_half_mirror row_mask:0xf bank_mask:0xf
  v_cvt_pk_bf16_f32 v12, v12, v12
  v_lshlrev_b32 v12, 16, v12
  v_mul_f32 v12, s72, v12
  v_cvt_pk_bf16_f32 v12, v12, v12
  v_lshlrev_b32 v12, 16, v12
  v_cmp_gt_f32 vcc, v12, v6
  s_cbranch_vccnz L_rare_91
L_back_92:
  v_fma_f32 v14, v12, s71, v7
  v_exp_f32 v14, v14
  s_nop 0
  v_cvt_pk_bf16_f32 v13, v14, v14
  v_add_f32 v8, v8, v14
  v_and_b32 v20, v13, v2
  v_and_b32 v21, v13, v3
  v_and_b32 v22, v13, v4
  v_and_b32 v23, v13, v5
  s_waitcnt vmcnt(0)
  s_nop 1
  v_mfma_f32_16x16x32_bf16 v[36:39], v[20:23], v[76:79], v[36:39]
  v_mfma_f32_16x16x32_bf16 v[40:43], v[20:23], v[80:83], v[40:43]
  v_mfma_f32_16x16x32_bf16 v[44:47], v[20:23], v[84:87], v[44:47]
  s_branch L_tail
L_drain_16:
  v_dot2_f32_bf16 v9, v88, v24, 0
  v_dot2_f32_bf16 v10, v92, v28, 0
  v_dot2_f32_bf16 v11, v96, v32, 0
  v_dot2_f32_bf16 v9, v89, v25, v9
  v_dot2_f32_bf16 v10, v93, v29, v10
  v_dot2_f32_bf16 v11, v97, v33, v11
  v_dot2_f32_bf16 v9, v90, v26, v9
  v_dot2_f32_bf16 v10, v94, v30, v10
  v_dot2_f32_bf16 v11, v98, v34, v11
  v_dot2_f32_bf16 v9, v91, v27, v9
  v_dot2_f32_bf16 v10, v95, v31, v10
  v_dot2_f32_bf16 v11, v99, v35, v11
  s_nop 1
  v_add_f32 v12, v9, v10
  v_add_f32 v12, v12, v11
  s_nop 1
  v_add_f32_dpp v12, v12, v12 quad_perm:[1,0,3,2] row_mask:0xf bank_mask:0xf
  s_nop 1
  v_add_f32_dpp v12, v12, v12 quad_perm:[2,3,0,1] row_mask:0xf bank_mask:0xf
  s_nop 1
  v_add_f32_dpp v12, v12, v12 row_half_mirror row_mask:0xf bank_mask:0xf
  v_cvt_pk_bf16_f32 v12, v12, v12
  v_lshlrev_b32 v12, 16, v12
  v_mul_f32 v12, s72, v12
  v_cvt_pk_bf16_f32 v12, v12, v12
  v_lshlrev_b32 v12, 16, v12
  v_cmp_gt_f32 vcc, v12, v6
  s_cbranch_vccnz L_rare_93
L_back_94:
  v_fma_f32 v14, v12, s71, v7
  v_exp_f32 v14, v14
  s_nop 0
  v_cvt_pk_bf16_f32 v13, v14, v14
  v_add_f32 v8, v8, v14
  v_and_b32 v20, v13, v2
  v_and_b32 v21, v13, v3
  v_and_b32 v22, v13, v4
  v_and_b32 v23, v13, v5
  s_waitcnt vmcnt(0)
  s_nop 1
  v_mfma_f32_16x16x32_bf16 v[36:39], v[20:23], v[100:103], v[36:39]
  v_mfma_f32_16x16x32_bf16 v[40:43], v[20:23], v[104:107], v[40:43]
  v_mfma_f32_16x16x32_bf16 v[44:47], v[20:23], v[108:111], v[44:47]
L_tail:
  s_nop 3
  v_add_f32_dpp v12, v8, v8 row_ror:8 row_mask:0xf bank_mask:0xf
  s_mov_b32 exec_lo, 0x00010001
  s_mov_b32 exec_hi, 0x00010001
  ds_write_b32 v18, v12 offset:6144
  ds_write_b32 v17, v7 offset:6208
  s_mov_b32 exec_lo, 0x00ff00ff
  s_mov_b32 exec_hi, 0xff00ff00
  v_mov_b32 v14, 1
  v_and_b32 v9, -16, v17
  s_nop 1
  ds_write_b128 v19, v[36:39] offset:0
  ds_write_b128 v19, v[40:43] offset:256
  ds_write_b128 v19, v[44:47] offset:512
  s_mov_b64 exec, 1
  ds_add_u32 v9, v14 offset:6224
  s_mov_b64 exec, -1
  s_cmp_ge_u32 s100, 32
  s_cbranch_scc1 L_sdone
  s_cmp_eq_u32 s3, 0
  s_cbranch_scc1 L_sdone
  ds_read_b32 v13, v15 offset:20
  ds_read_b32 v1, v15 offset:0
  v_mbcnt_lo_u32_b32 v0, -1, 0
  v_mbcnt_hi_u32_b32 v0, -1, v0
  s_sub_u32 s13, s3, 1
  s_waitcnt lgkmcnt(0)
  v_readfirstlane_b32 s82, v13
  v_lshlrev_b32 v2, 4, v0
  s_lshl_b32 s74, s13, 13
  s_add_u32 s74, s74, 4352
  v_add_u32 v13, s74, v2
  v_and_b32 v14, 15, v0
  v_mul_u32_u24 v14, 384, v14
  v_and_b32 v12, 48, v0
  v_add3_u32 v14, v14, v12, s74
  v_lshlrev_b32 v3, 8, v12
  s_and_b32 s77, s100, 1
  s_lshl_b32 s77, s77, 7
  s_add_u32 s77, s77, s5
  s_lshl_b32 s77, s77, 7
  s_add_u32 s77, s77, 20480
  s_add_u32 s78, s77, 64
  s_lshr_b32 s74, s100, 4
  s_lshl_b32 s74, s74, 3
  s_add_u32 s77, s77, s74
  s_lshl_b32 s74, s13, 4
  s_add_u32 s77, s77, s74
  s_lshl_b32 s73, s100, 2
  s_add_u32 s73, s73, s13
  s_mul_i32 s73, s73, 6144
  s_add_u32 s73, s73, 380928
  s_lshl_b32 s76, s101, 17
  s_lshl_b32 s74, s100, 9
  s_add_u32 s76, s76, s74
  s_lshl_b32 s74, s13, 15
  s_add_u32 s76, s76, s74
  s_add_u32 s76, s76, 1298432
  v_and_b32 v6, 8, v0
  v_lshlrev_b32 v6, 11, v6
  v_and_b32 v12, 7, v0
  v_lshl_add_u32 v6, v12, 6, v6
  v_and_b32 v12, 48, v0
  v_add_u32 v6, v6, v12
  v_lshlrev_b32 v7, 4, v0
  v_add_u32 v7, 75264, v7
  s_cmp_eq_u32 s82, 0
  s_cbranch_scc1 L_sj1
  s_add_u32 s74, s73, 4096
  buffer_load_dwordx4 v[16:19], v2, s[52:55], s73 offen offset:0 sc1
  buffer_load_dwordx4 v[20:23], v2, s[52:55], s73 offen offset:1024 sc1
  buffer_load_dwordx4 v[24:27], v2, s[52:55], s73 offen offset:2048 sc1
  buffer_load_dwordx4 v[28:31], v2, s[52:55], s73 offen offset:3072 sc1
  buffer_load_dwordx4 v[32:35], v2, s[52:55], s74 offen offset:0 sc1
  buffer_load_dwordx4 v[36:39], v2, s[52:55], s74 offen offset:1024 sc1
  buffer_load_dwordx2 v[40:41], v3, s[52:55], s77 offen offset:0 sc1
  buffer_load_dwordx2 v[42:43], v3, s[52:55], s77 offen offset:1024 sc1
  buffer_load_dwordx2 v[44:45], v3, s[52:55], s77 offen offset:2048 sc1
  buffer_load_dwordx2 v[46:47], v3, s[52:55], s77 offen offset:3072 sc1
L_sj1:
  ds_read_b128 v[64:67], v7 offset:0
  ds_read_b128 v[68:71], v7 offset:1024
  ds_read_b128 v[72:75], v7 offset:2048
  ds_read_b128 v[76:79], v7 offset:3072
  ds_read_b128 v[80:83], v7 offset:4096
  ds_read_b128 v[84:87], v7 offset:5120
  ds_read_b128 v[88:91], v7 offset:6144
  ds_read_b128 v[92:95], v7 offset:7168
  ds_read_b128 v[96:99], v7 offset:8192
  ds_read_b128 v[100:103], v7 offset:9216
  ds_read_b128 v[104:107], v7 offset:10240
  ds_read_b128 v[108:111], v7 offset:11264
  ds_read_b128 v[112:115], v7 offset:12288
  ds_read_b128 v[116:119], v7 offset:13312
  ds_read_b128 v[120:123], v7 offset:14336
  ds_read_b128 v[124:127], v7 offset:15360
  ds_read_b128 v[128:131], v7 offset:16384
  ds_read_b128 v[132:135], v7 offset:17408
  ds_read_b128 v[136:139], v7 offset:18432
  ds_read_b128 v[140:143], v7 offset:19456
  ds_read_b128 v[144:147], v7 offset:20480
  ds_read_b128 v[148:151], v7 offset:21504
  ds_read_b128 v[152:155], v7 offset:22528
  ds_read_b128 v[156:159], v7 offset:23552
  ds_read_b128 v[160:163], v7 offset:24576
  ds_read_b128 v[164:167], v7 offset:25600
  ds_read_b128 v[168:171], v7 offset:26624
  ds_read_b128 v[172:175], v7 offset:27648
  ds_read_b128 v[176:179], v7 offset:28672
  ds_read_b128 v[180:183], v7 offset:29696
  ds_read_b128 v[184:187], v7 offset:30720
  ds_read_b128 v[188:191], v7 offset:31744
  ds_read_b128 v[192:195], v7 offset:32768
  ds_read_b128 v[196:199], v7 offset:33792
  ds_read_b128 v[200:203], v7 offset:34816
  ds_read_b128 v[204:207], v7 offset:35840
  ds_read_b128 v[208:211], v7 offset:36864
  ds_read_b128 v[212:215], v7 offset:37888
  ds_read_b128 v[216:219], v7 offset:38912
  ds_read_b128 v[220:223], v7 offset:39936
  ds_read_b128 v[224:227], v7 offset:40960
  ds_read_b128 v[228:231], v7 offset:41984
  ds_read_b128 v[232:235], v7 offset:43008
  ds_read_b128 v[236:239], v7 offset:44032
  ds_read_b128 v[240:243], v7 offset:45056
  ds_read_b128 v[244:247], v7 offset:46080
  ds_read_b128 v[248:251], v7 offset:47104
  ds_read_b128 v[252:255], v7 offset:48128
  s_cmp_lg_u32 s82, 0
  s_cbranch_scc1 L_job_wait
  s_mov_b32 s81, 1048576
L_sgo:
  ds_read_b32 v12, v15 offset:20
  s_waitcnt lgkmcnt(0)
  v_readfirstlane_b32 s83, v12
  s_nop 0
  s_cmp_lg_u32 s83, 0
  s_cbranch_scc1 L_sgo_ok
  s_sleep 1
  s_sub_u32 s81, s81, 1
  s_cmp_lg_u32 s81, 0
  s_cbranch_scc1 L_sgo
L_sgo_ok:
  s_branch L_job_dense
L_sdone:
  s_endpgm
L_tkwait:
  s_mov_b32 s81, 1048576
L_tkw1:
  ds_read_b32 v13, v112 offset:3328
  s_waitcnt lgkmcnt(0)
  v_readfirstlane_b32 s42, v13
  s_sub_u32 s81, s81, 1
  s_cselect_b32 s42, -2, s42
  s_cmp_eq_u32 s42, -1
  s_cbranch_scc1 L_tkw1
  s_setpc_b64 s[14:15]
L_newmax:
  v_max_f32_dpp v13, v12, v12 row_ror:8 row_mask:0xf bank_mask:0xf
  s_nop 0
  v_readlane_b32 s73, v13, 0
  v_readlane_b32 s74, v13, 16
  v_readlane_b32 s75, v13, 32
  v_readlane_b32 s76, v13, 48
  s_nop 1
  v_max_f32 v6, s73, v6
  v_max_f32 v6, s74, v6
  v_max_f32 v6, s75, v6
  v_max_f32 v6, s76, v6
  v_mul_f32 v13, s71, v6
  v_sub_f32 v14, 0, v13
  v_sub_f32 v13, v14, v7
  v_exp_f32 v13, v13
  v_mov_b32 v7, v14
  v_mul_f32 v8, v8, v13
  v_mul_f32 v36, v36, v13
  v_mul_f32 v37, v37, v13
  v_mul_f32 v38, v38, v13
  v_mul_f32 v39, v39, v13
  v_mul_f32 v40, v40, v13
  v_mul_f32 v41, v41, v13
  v_mul_f32 v42, v42, v13
  v_mul_f32 v43, v43, v13
  v_mul_f32 v44, v44, v13
  v_mul_f32 v45, v45, v13
  v_mul_f32 v46, v46, v13
  v_mul_f32 v47, v47, v13
  s_setpc_b64 s[14:15]
L_tw_9:
  s_call_b64 s[14:15], L_tkwait
  s_branch L_tb_10
L_tw_12:
  s_call_b64 s[14:15], L_tkwait
  s_branch L_tb_13
L_rare_14:
  s_call_b64 s[14:15], L_newmax
  s_branch L_back_15
L_tw_17:
  s_call_b64 s[14:15], L_tkwait
  s_branch L_tb_18
L_rare_19:
  s_call_b64 s[14:15], L_newmax
  s_branch L_back_20
L_rare_91:
  s_call_b64 s[14:15], L_newmax
  s_branch L_back_92
L_rare_93:
  s_call_b64 s[14:15], L_newmax
  s_branch L_back_94
L_M:
  s_lshr_b32 s77, s2, 1
  s_and_b32 s78, s2, 1
  v_bfe_u32 v3, v0, 2, 2
  v_mul_u32_u24 v3, 1280, v3
  v_and_b32 v4, 48, v0
  v_add_u32 v3, v3, v4
  v_bfe_u32 v4, v0, 1, 1
  v_mul_u32_u24 v4, 320, v4
  v_add_u32 v3, v3, v4
  v_lshrrev_b32 v2, 4, v0
  v_mul_u32_u24 v2, 98304, v2
  v_and_b32 v4, 7, v0
  v_lshl_add_u32 v2, v4, 4, v2
  v_bfe_u32 v4, v0, 3, 1
  v_mul_u32_u24 v4, 1966080, v4
  v_add_u32 v2, v2, v4
  v_mov_b32 v5, 0
  v_mov_b32 v8, -1
  v_mov_b32 v9, -1
  v_mov_b32 v10, -1
  v_mov_b32 v11, -1
  s_waitcnt lgkmcnt(0)
  s_mov_b32 s52, s40
  s_mov_b32 s53, s41
  s_mov_b32 s54, 2150400
  s_mov_b32 s55, 0x00020000
  s_mov_b32 s64, s16
  s_mov_b32 s65, s17
  s_mov_b32 s66, 5120
  s_mov_b32 s67, 0x00020000
  s_mov_b32 s56, s22
  s_mov_b32 s57, s23
  s_mov_b32 s58, 7864320
  s_mov_b32 s59, 0x00020000
  buffer_load_dword v1, v5, s[52:55], 0 offen offset:0 sc1
  s_cmp_ge_u32 s2, 192
  s_cbranch_scc1 L_noq
  s_mul_i32 s73, s78, 640
  buffer_load_dwordx4 v[64:67], v3, s[64:67], s73 offen offset:0
  buffer_load_dwordx4 v[68:71], v3, s[64:67], s73 offen offset:64
  buffer_load_dwordx4 v[72:75], v3, s[64:67], s73 offen offset:128
  buffer_load_dwordx4 v[76:79], v3, s[64:67], s73 offen offset:192
  buffer_load_dwordx4 v[80:83], v3, s[64:67], s73 offen offset:256
  s_mul_i32 s73, s78, 3932160
  s_lshl_b32 s74, s77, 7
  s_add_u32 s73, s73, s74
  buffer_load_dwordx4 v[84:87], v2, s[56:59], s73 offen nt
  s_add_u32 s73, s73, 12288
  buffer_load_dwordx4 v[88:91], v2, s[56:59], s73 offen nt
  s_add_u32 s73, s73, 12288
  buffer_load_dwordx4 v[92:95], v2, s[56:59], s73 offen nt
  s_add_u32 s73, s73, 12288
  buffer_load_dwordx4 v[96:99], v2, s[56:59], s73 offen nt
  s_add_u32 s73, s73, 12288
  buffer_load_dwordx4 v[100:103], v2, s[56:59], s73 offen nt
  s_add_u32 s73, s73, 12288
  buffer_load_dwordx4 v[104:107], v2, s[56:59], s73 offen nt
  s_add_u32 s73, s73, 12288
  buffer_load_dwordx4 v[108:111], v2, s[56:59], s73 offen nt
  s_add_u32 s73, s73, 12288
  buffer_load_dwordx4 v[112:115], v2, s[56:59], s73 offen nt
  s_add_u32 s73, s73, 307200
  buffer_load_dwordx4 v[116:119], v2, s[56:59], s73 offen nt
  s_add_u32 s73, s73, 12288
  buffer_load_dwordx4 v[120:123], v2, s[56:59], s73 offen nt
  s_add_u32 s73, s73, 12288
  buffer_load_dwordx4 v[124:127], v2, s[56:59], s73 offen nt
  s_add_u32 s73, s73, 12288
  buffer_load_dwordx4 v[128:131], v2, s[56:59], s73 offen nt
  s_add_u32 s73, s73, 12288
  buffer_load_dwordx4 v[132:135], v2, s[56:59], s73 offen nt
  s_add_u32 s73, s73, 12288
  buffer_load_dwordx4 v[136:139], v2, s[56:59], s73 offen nt
  s_add_u32 s73, s73, 12288
  buffer_load_dwordx4 v[140:143], v2, s[56:59], s73 offen nt
  s_add_u32 s73, s73, 12288
  buffer_load_dwordx4 v[144:147], v2, s[56:59], s73 offen nt
  s_add_u32 s73, s73, 307200
  buffer_load_dwordx4 v[148:151], v2, s[56:59], s73 offen nt
  s_add_u32 s73, s73, 12288
  buffer_load_dwordx4 v[152:155], v2, s[56:59], s73 offen nt
  s_add_u32 s73, s73, 12288
  buffer_load_dwordx4 v[156:159], v2, s[56:59], s73 offen nt
  s_add_u32 s73, s73, 12288
  buffer_load_dwordx4 v[160:163], v2, s[56:59], s73 offen nt
  s_add_u32 s73, s73, 12288
  buffer_load_dwordx4 v[164:167], v2, s[56:59], s73 offen nt
  s_add_u32 s73, s73, 12288
  buffer_load_dwordx4 v[168:171], v2, s[56:59], s73 offen nt
  s_add_u32 s73, s73, 12288
  buffer_load_dwordx4 v[172:175], v2, s[56:59], s73 offen nt
  s_add_u32 s73, s73, 12288
  buffer_load_dwordx4 v[176:179], v2, s[56:59], s73 offen nt
  s_add_u32 s73, s73, 307200
  buffer_load_dwordx4 v[180:183], v2, s[56:59], s73 offen nt
  s_add_u32 s73, s73, 12288
  buffer_load_dwordx4 v[184:187], v2, s[56:59], s73 offen nt
  s_add_u32 s73, s73, 12288
  buffer_load_dwordx4 v[188:191], v2, s[56:59], s73 offen nt
  s_add_u32 s73, s73, 12288
  buffer_load_dwordx4 v[192:195], v2, s[56:59], s73 offen nt
  s_add_u32 s73, s73, 12288
  buffer_load_dwordx4 v[196:199], v2, s[56:59], s73 offen nt
  s_add_u32 s73, s73, 12288
  buffer_load_dwordx4 v[200:203], v2, s[56:59], s73 offen nt
  s_add_u32 s73, s73, 12288
  buffer_load_dwordx4 v[204:207], v2, s[56:59], s73 offen nt
  s_add_u32 s73, s73, 12288
  buffer_load_dwordx4 v[208:211], v2, s[56:59], s73 offen nt
  s_add_u32 s73, s73, 307200
  buffer_load_dwordx4 v[212:215], v2, s[56:59], s73 offen nt
  s_add_u32 s73, s73, 12288
  buffer_load_dwordx4 v[216:219], v2, s[56:59], s73 offen nt
  s_add_u32 s73, s73, 12288
  buffer_load_dwordx4 v[220:223], v2, s[56:59], s73 offen nt
  s_add_u32 s73, s73, 12288
  buffer_load_dwordx4 v[224:227], v2, s[56:59], s73 offen nt
  s_add_u32 s73, s73, 12288
  buffer_load_dwordx4 v[228:231], v2, s[56:59], s73 offen nt
  s_add_u32 s73, s73, 12288
  buffer_load_dwordx4 v[232:235], v2, s[56:59], s73 offen nt
  s_add_u32 s73, s73, 12288
  buffer_load_dwordx4 v[236:239], v2, s[56:59], s73 offen nt
  s_add_u32 s73, s73, 12288
  buffer_load_dwordx4 v[240:243], v2, s[56:59], s73 offen nt
  s_add_u32 s73, s73, 307200
L_noq:
  v_lshlrev_b32 v7, 3, v0
  s_lshl_b32 s75, s7, 4
  s_add_u32 s75, s75, s6
  s_lshl_b32 s75, s75, 9
  s_add_u32 s75, s75, 1167360
  buffer_store_dwordx2 v[8:9], v7, s[52:55], s75 offen sc1
  s_mul_i32 s12, s7, 4352
  s_add_u32 s12, s12, 53248
  s_cmp_eq_u32 s6, 0
  s_cselect_b32 s75, s12, 2150400
  s_mov_b64 exec, 1
  buffer_store_dword v5, v5, s[52:55], s75 offen sc1
  s_mov_b64 exec, -1
  v_and_b32 v6, 7, v0
  v_mul_u32_u24 v6, 6272, v6
  v_add_u32 v6, 10576, v6
  ds_write_b32 v6, v5
  ds_write_b32 v5, v5 offset:4
  ds_write_b32 v5, v5 offset:8
  ds_write_b32 v5, v5 offset:12
  ds_write_b32 v5, v5 offset:16
  ds_write_b32 v5, v5 offset:20
  ds_write_b32 v5, v5 offset:24
  ds_write_b32 v5, v5 offset:28
  v_lshlrev_b32 v6, 4, v0
  v_add_u32 v6, 3328, v6
  ds_write_b128 v6, v[8:11]
  s_cmp_ge_u32 s2, 192
  s_cbranch_scc1 L_noq2
  v_lshrrev_b32 v6, 4, v0
  v_mul_u32_u24 v6, 24576, v6
  v_and_b32 v4, 7, v0
  v_lshl_add_u32 v6, v4, 5, v6
  v_and_b32 v4, 8, v0
  v_lshl_add_u32 v6, v4, 1, v6
  s_mul_i32 s73, s78, 98304
  s_lshl_b32 s74, s77, 8
  s_add_u32 s73, s73, s74
  s_add_u32 s73, s73, 184320
  s_waitcnt vmcnt(34)
  v_perm_b32 v48, v88, v84, s79
  v_perm_b32 v49, v96, v92, s79
  v_perm_b32 v50, v104, v100, s79
  v_perm_b32 v51, v112, v108, s79
  v_perm_b32 v52, v88, v84, s80
  v_perm_b32 v53, v96, v92, s80
  v_perm_b32 v54, v104, v100, s80
  v_perm_b32 v55, v112, v108, s80
  v_perm_b32 v56, v89, v85, s79
  v_perm_b32 v57, v97, v93, s79
  v_perm_b32 v58, v105, v101, s79
  v_perm_b32 v59, v113, v109, s79
  v_perm_b32 v60, v89, v85, s80
  v_perm_b32 v61, v97, v93, s80
  v_perm_b32 v62, v105, v101, s80
  v_perm_b32 v63, v113, v109, s80
  s_nop 1
  v_mfma_f32_16x16x32_bf16 v[16:19], v[64:67], v[48:51], 0
  v_mfma_f32_16x16x32_bf16 v[20:23], v[64:67], v[52:55], 0
  v_mfma_f32_16x16x32_bf16 v[24:27], v[64:67], v[56:59], 0
  v_mfma_f32_16x16x32_bf16 v[28:31], v[64:67], v[60:63], 0
  v_perm_b32 v48, v90, v86, s79
  v_perm_b32 v49, v98, v94, s79
  v_perm_b32 v50, v106, v102, s79
  v_perm_b32 v51, v114, v110, s79
  v_perm_b32 v52, v90, v86, s80
  v_perm_b32 v53, v98, v94, s80
  v_perm_b32 v54, v106, v102, s80
  v_perm_b32 v55, v114, v110, s80
  v_perm_b32 v56, v91, v87, s79
  v_perm_b32 v57, v99, v95, s79
  v_perm_b32 v58, v107, v103, s79
  v_perm_b32 v59, v115, v111, s79
  v_perm_b32 v60, v91, v87, s80
  v_perm_b32 v61, v99, v95, s80
  v_perm_b32 v62, v107, v103, s80
  v_perm_b32 v63, v115, v111, s80
  s_nop 1
  v_mfma_f32_16x16x32_bf16 v[32:35], v[64:67], v[48:51], 0
  v_mfma_f32_16x16x32_bf16 v[36:39], v[64:67], v[52:55], 0
  v_mfma_f32_16x16x32_bf16 v[40:43], v[64:67], v[56:59], 0
  v_mfma_f32_16x16x32_bf16 v[44:47], v[64:67], v[60:63], 0
  s_waitcnt vmcnt(26)
  v_perm_b32 v48, v120, v116, s79
  v_perm_b32 v49, v128, v124, s79
  v_perm_b32 v50, v136, v132, s79
  v_perm_b32 v51, v144, v140, s79
  v_perm_b32 v52, v120, v116, s80
  v_perm_b32 v53, v128, v124, s80
  v_perm_b32 v54, v136, v132, s80
  v_perm_b32 v55, v144, v140, s80
  v_perm_b32 v56, v121, v117, s79
  v_perm_b32 v57, v129, v125, s79
  v_perm_b32 v58, v137, v133, s79
  v_perm_b32 v59, v145, v141, s79
  v_perm_b32 v60, v121, v117, s80
  v_perm_b32 v61, v129, v125, s80
  v_perm_b32 v62, v137, v133, s80
  v_perm_b32 v63, v145, v141, s80
  s_nop 1
  v_mfma_f32_16x16x32_bf16 v[16:19], v[68:71], v[48:51], v[16:19]
  v_mfma_f32_16x16x32_bf16 v[20:23], v[68:71], v[52:55], v[20:23]
  v_mfma_f32_16x16x32_bf16 v[24:27], v[68:71], v[56:59], v[24:27]
  v_mfma_f32_16x16x32_bf16 v[28:31], v[68:71], v[60:63], v[28:31]
  v_perm_b32 v48, v122, v118, s79
  v_perm_b32 v49, v130, v126, s79
  v_perm_b32 v50, v138, v134, s79
  v_perm_b32 v51, v146, v142, s79
  v_perm_b32 v52, v122, v118, s80
  v_perm_b32 v53, v130, v126, s80
  v_perm_b32 v54, v138, v134, s80
  v_perm_b32 v55, v146, v142, s80
  v_perm_b32 v56, v123, v119, s79
  v_perm_b32 v57, v131, v127, s79
  v_perm_b32 v58, v139, v135, s79
  v_perm_b32 v59, v147, v143, s79
  v_perm_b32 v60, v123, v119, s80
  v_perm_b32 v61, v131, v127, s80
  v_perm_b32 v62, v139, v135, s80
  v_perm_b32 v63, v147, v143, s80
  s_nop 1
  v_mfma_f32_16x16x32_bf16 v[32:35], v[68:71], v[48:51], v[32:35]
  v_mfma_f32_16x16x32_bf16 v[36:39], v[68:71], v[52:55], v[36:39]
  v_mfma_f32_16x16x32_bf16 v[40:43], v[68:71], v[56:59], v[40:43]
  v_mfma_f32_16x16x32_bf16 v[44:47], v[68:71], v[60:63], v[44:47]
  s_waitcnt vmcnt(18)
  v_perm_b32 v48, v152, v148, s79
  v_perm_b32 v49, v160, v156, s79
  v_perm_b32 v50, v168, v164, s79
  v_perm_b32 v51, v176, v172, s79
  v_perm_b32 v52, v152, v148, s80
  v_perm_b32 v53, v160, v156, s80
  v_perm_b32 v54, v168, v164, s80
  v_perm_b32 v55, v176, v172, s80
  v_perm_b32 v56, v153, v149, s79
  v_perm_b32 v57, v161, v157, s79
  v_perm_b32 v58, v169, v165, s79
  v_perm_b32 v59, v177, v173, s79
  v_perm_b32 v60, v153, v149, s80
  v_perm_b32 v61, v161, v157, s80
  v_perm_b32 v62, v169, v165, s80
  v_perm_b32 v63, v177, v173, s80
  s_nop 1
  v_mfma_f32_16x16x32_bf16 v[16:19], v[72:75], v[48:51], v[16:19]
  v_mfma_f32_16x16x32_bf16 v[20:23], v[72:75], v[52:55], v[20:23]
  v_mfma_f32_16x16x32_bf16 v[24:27], v[72:75], v[56:59], v[24:27]
  v_mfma_f32_16x16x32_bf16 v[28:31], v[72:75], v[60:63], v[28:31]
  v_perm_b32 v48, v154, v150, s79
  v_perm_b32 v49, v162, v158, s79
  v_perm_b32 v50, v170, v166, s79
  v_perm_b32 v51, v178, v174, s79
  v_perm_b32 v52, v154, v150, s80
  v_perm_b32 v53, v162, v158, s80
  v_perm_b32 v54, v170, v166, s80
  v_perm_b32 v55, v178, v174, s80
  v_perm_b32 v56, v155, v151, s79
  v_perm_b32 v57, v163, v159, s79
  v_perm_b32 v58, v171, v167, s79
  v_perm_b32 v59, v179, v175, s79
  v_perm_b32 v60, v155, v151, s80
  v_perm_b32 v61, v163, v159, s80
  v_perm_b32 v62, v171, v167, s80
  v_perm_b32 v63, v179, v175, s80
  s_nop 1
  v_mfma_f32_16x16x32_bf16 v[32:35], v[72:75], v[48:51], v[32:35]
  v_mfma_f32_16x16x32_bf16 v[36:39], v[72:75], v[52:55], v[36:39]
  v_mfma_f32_16x16x32_bf16 v[40:43], v[72:75], v[56:59], v[40:43]
  v_mfma_f32_16x16x32_bf16 v[44:47], v[72:75], v[60:63], v[44:47]
  s_waitcnt vmcnt(10)
  v_perm_b32 v48, v184, v180, s79
  v_perm_b32 v49, v192, v188, s79
  v_perm_b32 v50, v200, v196, s79
  v_perm_b32 v51, v208, v204, s79
  v_perm_b32 v52, v184, v180, s80
  v_perm_b32 v53, v192, v188, s80
  v_perm_b32 v54, v200, v196, s80
  v_perm_b32 v55, v208, v204, s80
  v_perm_b32 v56, v185, v181, s79
  v_perm_b32 v57, v193, v189, s79
  v_perm_b32 v58, v201, v197, s79
  v_perm_b32 v59, v209, v205, s79
  v_perm_b32 v60, v185, v181, s80
  v_perm_b32 v61, v193, v189, s80
  v_perm_b32 v62, v201, v197, s80
  v_perm_b32 v63, v209, v205, s80
  s_nop 1
  v_mfma_f32_16x16x32_bf16 v[16:19], v[76:79], v[48:51], v[16:19]
  v_mfma_f32_16x16x32_bf16 v[20:23], v[76:79], v[52:55], v[20:23]
  v_mfma_f32_16x16x32_bf16 v[24:27], v[76:79], v[56:59], v[24:27]
  v_mfma_f32_16x16x32_bf16 v[28:31], v[76:79], v[60:63], v[28:31]
  v_perm_b32 v48, v186, v182, s79
  v_perm_b32 v49, v194, v190, s79
  v_perm_b32 v50, v202, v198, s79
  v_perm_b32 v51, v210, v206, s79
  v_perm_b32 v52, v186, v182, s80
  v_perm_b32 v53, v194, v190, s80
  v_perm_b32 v54, v202, v198, s80
  v_perm_b32 v55, v210, v206, s80
  v_perm_b32 v56, v187, v183, s79
  v_perm_b32 v57, v195, v191, s79
  v_perm_b32 v58, v203, v199, s79
  v_perm_b32 v59, v211, v207, s79
  v_perm_b32 v60, v187, v183, s80
  v_perm_b32 v61, v195, v191, s80
  v_perm_b32 v62, v203, v199, s80
  v_perm_b32 v63, v211, v207, s80
  s_nop 1
  v_mfma_f32_16x16x32_bf16 v[32:35], v[76:79], v[48:51], v[32:35]
  v_mfma_f32_16x16x32_bf16 v[36:39], v[76:79], v[52:55], v[36:39]
  v_mfma_f32_16x16x32_bf16 v[40:43], v[76:79], v[56:59], v[40:43]
  v_mfma_f32_16x16x32_bf16 v[44:47], v[76:79], v[60:63], v[44:47]
  s_waitcnt vmcnt(2)
  v_perm_b32 v48, v216, v212, s79
  v_perm_b32 v49, v224, v220, s79
  v_perm_b32 v50, v232, v228, s79
  v_perm_b32 v51, v240, v236, s79
  v_perm_b32 v52, v216, v212, s80
  v_perm_b32 v53, v224, v220, s80
  v_perm_b32 v54, v232, v228, s80
  v_perm_b32 v55, v240, v236, s80
  v_perm_b32 v56, v217, v213, s79
  v_perm_b32 v57, v225, v221, s79
  v_perm_b32 v58, v233, v229, s79
  v_perm_b32 v59, v241, v237, s79
  v_perm_b32 v60, v217, v213, s80
  v_perm_b32 v61, v225, v221, s80
  v_perm_b32 v62, v233, v229, s80
  v_perm_b32 v63, v241, v237, s80
  s_nop 1
  v_mfma_f32_16x16x32_bf16 v[16:19], v[80:83], v[48:51], v[16:19]
  v_mfma_f32_16x16x32_bf16 v[20:23], v[80:83], v[52:55], v[20:23]
  v_mfma_f32_16x16x32_bf16 v[24:27], v[80:83], v[56:59], v[24:27]
  v_mfma_f32_16x16x32_bf16 v[28:31], v[80:83], v[60:63], v[28:31]
  v_perm_b32 v48, v218, v214, s79
  v_perm_b32 v49, v226, v222, s79
  v_perm_b32 v50, v234, v230, s79
  v_perm_b32 v51, v242, v238, s79
  v_perm_b32 v52, v218, v214, s80
  v_perm_b32 v53, v226, v222, s80
  v_perm_b32 v54, v234, v230, s80
  v_perm_b32 v55, v242, v238, s80
  v_perm_b32 v56, v219, v215, s79
  v_perm_b32 v57, v227, v223, s79
  v_perm_b32 v58, v235, v231, s79
  v_perm_b32 v59, v243, v239, s79
  v_perm_b32 v60, v219, v215, s80
  v_perm_b32 v61, v227, v223, s80
  v_perm_b32 v62, v235, v231, s80
  v_perm_b32 v63, v243, v239, s80
  s_nop 1
  v_mfma_f32_16x16x32_bf16 v[32:35], v[80:83], v[48:51], v[32:35]
  v_mfma_f32_16x16x32_bf16 v[36:39], v[80:83], v[52:55], v[36:39]
  v_mfma_f32_16x16x32_bf16 v[40:43], v[80:83], v[56:59], v[40:43]
  v_mfma_f32_16x16x32_bf16 v[44:47], v[80:83], v[60:63], v[44:47]
  v_and_b32 v4, 8, v0
  v_cmp_eq_u32 vcc, 0, v4
  s_nop 6
  v_cndmask_b32 v48, v18, v16, vcc
  v_cndmask_b32 v49, v22, v20, vcc
  v_cndmask_b32 v50, v26, v24, vcc
  v_cndmask_b32 v51, v30, v28, vcc
  v_cndmask_b32 v52, v34, v32, vcc
  v_cndmask_b32 v53, v38, v36, vcc
  v_cndmask_b32 v54, v42, v40, vcc
  v_cndmask_b32 v55, v46, v44, vcc
  v_add_f32_dpp v48, v48, v48 row_ror:8 row_mask:0xf bank_mask:0xf
  v_add_f32_dpp v49, v49, v49 row_ror:8 row_mask:0xf bank_mask:0xf
  v_add_f32_dpp v50, v50, v50 row_ror:8 row_mask:0xf bank_mask:0xf
  v_add_f32_dpp v51, v51, v51 row_ror:8 row_mask:0xf bank_mask:0xf
  v_add_f32_dpp v52, v52, v52 row_ror:8 row_mask:0xf bank_mask:0xf
  v_add_f32_dpp v53, v53, v53 row_ror:8 row_mask:0xf bank_mask:0xf
  v_add_f32_dpp v54, v54, v54 row_ror:8 row_mask:0xf bank_mask:0xf
  v_add_f32_dpp v55, v55, v55 row_ror:8 row_mask:0xf bank_mask:0xf
  v_cndmask_b32 v48, v52, v48, vcc
  v_cndmask_b32 v49, v53, v49, vcc
  v_cndmask_b32 v50, v54, v50, vcc
  v_cndmask_b32 v51, v55, v51, vcc
  buffer_store_dwordx4 v[48:51], v6, s[52:55], s73 offen sc1
L_noq2:
  s_waitcnt vmcnt(0)
  s_mov_b32 s74, 0x9E3779B1
  v_mul_lo_u32 v1, v1, s74
  v_add_u32 v1, 0x7F4A7C15, v1
  s_waitcnt vmcnt(0)
  s_lshl_b32 s75, s2, 5
  s_add_u32 s75, s75, 4096
  s_mov_b64 exec, 1
  buffer_store_dword v1, v5, s[52:55], s75 offen sc1
  s_mov_b64 exec, -1
  ds_write_b32 v5, v1 offset:0
  v_lshlrev_b32 v12, 3, v0
  s_mul_i32 s73, s6, 6
  v_add_u32 v6, s73, v0
  v_lshlrev_b32 v6, 5, v6
  s_mov_b32 s81, 262144
  s_mov_b32 exec_lo, 0x3f
  s_mov_b32 exec_hi, 0x0
  s_mov_b32 s75, 4096
L_pq0:
  buffer_load_dword v15, v6, s[52:55], s75 offen sc1
  s_waitcnt vmcnt(0)
  v_cmp_ne_u32 vcc, v15, v1
  s_cbranch_vccz L_pq0_ok
  s_sleep 1
  s_sub_u32 s81, s81, 1
  s_cmp_lg_u32 s81, 0
  s_cbranch_scc1 L_pq0
L_pq0_ok:
  s_mov_b64 exec, -1
  s_mul_i32 s73, s6, 768
  v_lshlrev_b32 v6, 4, v0
  v_add_u32 v6, s73, v6
  s_mov_b32 exec_lo, -1
  s_mov_b32 exec_hi, 0xffff
  s_mov_b32 s73, 184320
  buffer_load_dwordx4 v[96:99], v6, s[52:55], s73 offen sc1
  s_mov_b32 s73, 282624
  buffer_load_dwordx4 v[100:103], v6, s[52:55], s73 offen sc1
  s_waitcnt vmcnt(0)
  v_add_f32 v96, v96, v100
  v_add_f32 v97, v97, v101
  v_add_f32 v98, v98, v102
  v_add_f32 v99, v99, v103
  v_cvt_pk_bf16_f32 v100, v96, v97
  v_cvt_pk_bf16_f32 v101, v98, v99
  ds_write_b64 v12, v[100:101] offset:128
  s_mov_b64 exec, -1
  s_waitcnt lgkmcnt(0)
  s_barrier
  s_add_u32 s76, s6, 16
  s_mul_i32 s73, s76, 6
  v_add_u32 v6, s73, v0
  v_lshlrev_b32 v6, 5, v6
  s_mov_b32 s81, 262144
  s_mov_b32 exec_lo, 0x3f
  s_mov_b32 exec_hi, 0x0
  s_mov_b32 s75, 4096
L_pq1:
  buffer_load_dword v15, v6, s[52:55], s75 offen sc1
  s_waitcnt vmcnt(0)
  v_cmp_ne_u32 vcc, v15, v1
  s_cbranch_vccz L_pq1_ok
  s_sleep 8
  s_sub_u32 s81, s81, 1
  s_cmp_lg_u32 s81, 0
  s_cbranch_scc1 L_pq1
L_pq1_ok:
  s_mov_b64 exec, -1
  s_mul_i32 s73, s76, 768
  v_lshlrev_b32 v6, 4, v0
  v_add_u32 v6, s73, v6
  s_mov_b32 exec_lo, -1
  s_mov_b32 exec_hi, 0xffff
  s_mov_b32 s73, 184320
  buffer_load_dwordx4 v[96:99], v6, s[52:55], s73 offen sc1
  s_mov_b32 s73, 282624
  buffer_load_dwordx4 v[100:103], v6, s[52:55], s73 offen sc1
  s_mov_b32 s73, 208896
  buffer_load_dwordx4 v[104:107], v6, s[52:55], s73 offen sc1
  s_mov_b32 s73, 307200
  buffer_load_dwordx4 v[108:111], v6, s[52:55], s73 offen sc1
  s_mov_b32 s73, 233472
  buffer_load_dwordx4 v[112:115], v6, s[52:55], s73 offen sc1
  s_mov_b32 s73, 331776
  buffer_load_dwordx4 v[116:119], v6, s[52:55], s73 offen sc1
  s_waitcnt vmcnt(4)
  v_add_f32 v96, v96, v100
  v_add_f32 v97, v97, v101
  v_add_f32 v98, v98, v102
  v_add_f32 v99, v99, v103
  v_cvt_pk_bf16_f32 v100, v96, v97
  v_cvt_pk_bf16_f32 v101, v98, v99
  ds_write_b64 v12, v[100:101] offset:512
  s_waitcnt vmcnt(2)
  v_add_f32 v104, v104, v108
  v_add_f32 v105, v105, v109
  v_add_f32 v106, v106, v110
  v_add_f32 v107, v107, v111
  v_cvt_pk_bf16_f32 v108, v104, v105
  v_cvt_pk_bf16_f32 v109, v106, v107
  ds_write_b64 v12, v[108:109] offset:1280
  s_waitcnt vmcnt(0)
  v_add_f32 v112, v112, v116
  v_add_f32 v113, v113, v117
  v_add_f32 v114, v114, v118
  v_add_f32 v115, v115, v119
  v_cvt_pk_bf16_f32 v116, v112, v113
  v_cvt_pk_bf16_f32 v117, v114, v115
  ds_write_b64 v12, v[116:117] offset:2048
  s_mov_b64 exec, -1
  v_mov_b32 v13, 2
  ds_write_b32 v5, v13 offset:8
  s_mul_i32 s73, s6, 768
  v_lshlrev_b32 v6, 4, v0
  v_add_u32 v6, s73, v6
  s_mov_b32 exec_lo, -1
  s_mov_b32 exec_hi, 0xffff
  s_mov_b32 s73, 208896
  buffer_load_dwordx4 v[96:99], v6, s[52:55], s73 offen sc1
  s_mov_b32 s73, 307200
  buffer_load_dwordx4 v[100:103], v6, s[52:55], s73 offen sc1
  s_mov_b32 s73, 233472
  buffer_load_dwordx4 v[104:107], v6, s[52:55], s73 offen sc1
  s_mov_b32 s73, 331776
  buffer_load_dwordx4 v[108:111], v6, s[52:55], s73 offen sc1
  s_mov_b32 s73, 258048
  buffer_load_dwordx4 v[112:115], v6, s[52:55], s73 offen sc1
  s_mov_b32 s73, 356352
  buffer_load_dwordx4 v[116:119], v6, s[52:55], s73 offen sc1
  s_waitcnt vmcnt(4)
  v_add_f32 v96, v96, v100
  v_add_f32 v97, v97, v101
  v_add_f32 v98, v98, v102
  v_add_f32 v99, v99, v103
  v_cvt_pk_bf16_f32 v100, v96, v97
  v_cvt_pk_bf16_f32 v101, v98, v99
  ds_write_b64 v12, v[100:101] offset:896
  s_waitcnt vmcnt(2)
  v_add_f32 v104, v104, v108
  v_add_f32 v105, v105, v109
  v_add_f32 v106, v106, v110
  v_add_f32 v107, v107, v111
  v_cvt_pk_bf16_f32 v108, v104, v105
  v_cvt_pk_bf16_f32 v109, v106, v107
  ds_write_b64 v12, v[108:109] offset:1664
  s_waitcnt vmcnt(0)
  v_add_f32 v112, v112, v116
  v_add_f32 v113, v113, v117
  v_add_f32 v114, v114, v118
  v_add_f32 v115, v115, v119
  v_cvt_pk_bf16_f32 v116, v112, v113
  v_cvt_pk_bf16_f32 v117, v114, v115
  ds_write_b64 v12, v[116:117] offset:2432
  s_mov_b64 exec, -1
  v_mov_b32 v13, 7
  ds_write_b32 v5, v13 offset:8
  s_add_u32 s76, s7, 16
  s_mul_i32 s73, s76, 6
  v_add_u32 v6, s73, v0
  v_lshlrev_b32 v6, 5, v6
  s_mov_b32 s81, 262144
  s_mov_b32 exec_lo, 0x3f
  s_mov_b32 exec_hi, 0x0
  s_mov_b32 s75, 4096
L_pq2:
  buffer_load_dword v15, v6, s[52:55], s75 offen sc1
  s_waitcnt vmcnt(0)
  v_cmp_ne_u32 vcc, v15, v1
  s_cbranch_vccz L_pq2_ok
  s_sleep 8
  s_sub_u32 s81, s81, 1
  s_cmp_lg_u32 s81, 0
  s_cbranch_scc1 L_pq2
L_pq2_ok:
  s_mov_b64 exec, -1
  s_mul_i32 s73, s76, 768
  v_lshlrev_b32 v6, 4, v0
  v_add_u32 v6, s73, v6
  s_mov_b32 exec_lo, -1
  s_mov_b32 exec_hi, 0xffff
  s_mov_b32 s73, 258048
  buffer_load_dwordx4 v[96:99], v6, s[52:55], s73 offen sc1
  s_mov_b32 s73, 356352
  buffer_load_dwordx4 v[100:103], v6, s[52:55], s73 offen sc1
  s_waitcnt vmcnt(0)
  v_add_f32 v96, v96, v100
  v_add_f32 v97, v97, v101
  v_add_f32 v98, v98, v102
  v_add_f32 v99, v99, v103
  v_cvt_pk_bf16_f32 v100, v96, v97
  v_cvt_pk_bf16_f32 v101, v98, v99
  ds_write_b64 v12, v[100:101] offset:2816
  s_mov_b64 exec, -1
  v_mov_b32 v13, 8
  ds_write_b32 v5, v13 offset:8
  v_lshlrev_b32 v81, 4, v0
  v_add_u32 v81, 4352, v81
  v_lshlrev_b32 v82, 3, v0
  v_mov_b32 v84, 0
  v_mov_b32 v85, 0
  v_mov_b32 v80, 35712
  s_mov_b32 s81, 1048576
L_mw5:
  ds_read_b32 v72, v80 offset:6224
  s_waitcnt lgkmcnt(0)
  v_readfirstlane_b32 s83, v72
  s_nop 0
  s_cmp_eq_u32 s83, 4
  s_cbranch_scc1 L_mw5_ok
  s_sleep 32
  s_sub_u32 s81, s81, 1
  s_cmp_lg_u32 s81, 0
  s_cbranch_scc1 L_mw5
L_mw5_ok:
  v_mov_b32 v80, 4352
  s_mov_b32 s69, 0
  s_mov_b32 s78, 0
  s_lshl_b32 s77, s7, 4
  s_add_u32 s77, s77, s6
  s_lshl_b32 s77, s77, 9
  s_add_u32 s77, s77, 1167360
  s_lshl_b32 s76, s2, 7
  s_add_u32 s76, s76, 20480
L_merge:
  s_cmp_lt_u32 s69, 6
  s_cbranch_scc1 L_noserve
  s_cmp_eq_u32 s69, 7
  s_cbranch_scc1 L_serve_chk
  s_mov_b32 s70, 0
  s_mov_b32 s81, 1048576
L_mok:
  ds_read_b32 v72, v5 offset:4
  s_waitcnt lgkmcnt(0)
  v_readfirstlane_b32 s83, v72
  s_nop 0
  s_cmp_lg_u32 s83, 0
  s_cbranch_scc1 L_mok_ok
  s_sleep 8
  s_sub_u32 s81, s81, 1
  s_cmp_lg_u32 s81, 0
  s_cbranch_scc1 L_mok
L_mok_ok:
L_serve:
  s_mov_b32 s81, 1048576
L_mreq:
  ds_read_b32 v72, v5 offset:12
  s_waitcnt lgkmcnt(0)
  v_readfirstlane_b32 s83, v72
  s_nop 0
  s_cmp_gt_u32 s83, s70
  s_cbranch_scc1 L_mreq_ok
  s_sleep 1
  s_sub_u32 s81, s81, 1
  s_cmp_lg_u32 s81, 0
  s_cbranch_scc1 L_mreq
L_mreq_ok:
  s_mov_b32 s42, 1
  s_atomic_add s42, s[40:41], s12 glc
  v_mov_b32 v72, s70
  v_add_u32 v72, 3328, v72
  s_add_u32 s70, s70, 4
  s_waitcnt lgkmcnt(0)
  s_min_u32 s42, s42, 192
  v_mov_b32 v73, s42
  ds_write_b32 v72, v73
  s_cmp_eq_u32 s69, 6
  s_cbranch_scc1 L_noserve
L_serve_chk:
  s_cmp_lt_u32 s70, 1024
  s_cselect_b32 s42, s42, 192
  s_cmp_eq_u32 s78, 1
  s_cbranch_scc1 L_pubflag
  s_cmp_lg_u32 s78, 0
  s_cbranch_scc1 L_pubdone
  s_cmp_lt_u32 s42, 192
  s_cbranch_scc1 L_serve
  s_lshl_b32 s73, s6, 6
  s_add_u32 s73, s73, s8
  s_mul_i32 s73, s73, 384
  s_mov_b32 exec_hi, 0xffff
  s_add_u32 s74, s73, 380928
  buffer_store_dwordx2 v[100:101], v82, s[52:55], s74 offen sc1
  s_add_u32 s74, s73, 774144
  buffer_store_dwordx2 v[98:99], v82, s[52:55], s74 offen sc1
  s_add_u32 s74, s73, 387072
  buffer_store_dwordx2 v[96:97], v82, s[52:55], s74 offen sc1
  s_add_u32 s74, s73, 780288
  buffer_store_dwordx2 v[94:95], v82, s[52:55], s74 offen sc1
  s_add_u32 s74, s73, 393216
  buffer_store_dwordx2 v[92:93], v82, s[52:55], s74 offen sc1
  s_add_u32 s74, s73, 786432
  buffer_store_dwordx2 v[90:91], v82, s[52:55], s74 offen sc1
  s_add_u32 s74, s73, 399360
  buffer_store_dwordx2 v[88:89], v82, s[52:55], s74 offen sc1
  s_mov_b64 exec, 127
  buffer_store_dwordx2 v[84:85], v82, s[52:55], s76 offen sc1
  s_mov_b64 exec, -1
  v_mov_b32 v72, 1
  ds_write_b32 v5, v72 offset:16
  s_mov_b32 s78, 1
  s_cmp_lt_u32 s42, 192
  s_cbranch_scc1 L_serve
L_pubflag:
  s_waitcnt vmcnt(0)
  s_mov_b64 exec, 1
  buffer_store_dword v1, v5, s[52:55], s76 offen offset:64 sc1
  s_mov_b64 exec, -1
  s_mov_b32 s78, 2
L_pubdone:
  s_cmp_lt_u32 s42, 192
  s_cbranch_scc1 L_serve
L_noserve:
  s_mov_b32 s81, 1048576
L_mw:
  ds_read_b32 v72, v80 offset:6224
  s_waitcnt lgkmcnt(0)
  v_readfirstlane_b32 s83, v72
  s_nop 0
  s_cmp_eq_u32 s83, 4
  s_cbranch_scc1 L_mw_ok
  s_sleep 1
  s_sub_u32 s81, s81, 1
  s_cmp_lg_u32 s81, 0
  s_cbranch_scc1 L_mw
L_mw_ok:
  ds_read_b128 v[48:51], v80 offset:6208
  ds_read_b128 v[52:55], v80 offset:6144
  ds_read_b128 v[56:59], v80 offset:6160
  ds_read_b128 v[60:63], v80 offset:6176
  ds_read_b128 v[64:67], v80 offset:6192
  ds_read_b128 v[16:19], v81 offset:0
  ds_read_b128 v[20:23], v81 offset:768
  ds_read_b128 v[24:27], v81 offset:1536
  ds_read_b128 v[28:31], v81 offset:2304
  ds_read_b128 v[32:35], v81 offset:3072
  ds_read_b128 v[36:39], v81 offset:3840
  ds_read_b128 v[40:43], v81 offset:4608
  ds_read_b128 v[44:47], v81 offset:5376
  s_waitcnt lgkmcnt(8)
  v_min3_f32 v74, v48, v49, v50
  v_min_f32 v74, v74, v51
  v_sub_f32 v68, v74, v48
  v_sub_f32 v69, v74, v49
  v_sub_f32 v70, v74, v50
  v_sub_f32 v71, v74, v51
  v_exp_f32 v68, v68
  v_exp_f32 v69, v69
  v_exp_f32 v70, v70
  v_exp_f32 v71, v71
  v_add_f32 v52, v52, v53
  v_add_f32 v54, v54, v55
  v_add_f32 v52, v52, v54
  v_add_f32 v56, v56, v57
  v_add_f32 v58, v58, v59
  v_add_f32 v56, v56, v58
  v_add_f32 v60, v60, v61
  v_add_f32 v62, v62, v63
  v_add_f32 v60, v60, v62
  v_add_f32 v64, v64, v65
  v_add_f32 v66, v66, v67
  v_add_f32 v64, v64, v66
  v_mul_f32 v75, v68, v52
  v_fmac_f32 v75, v69, v56
  v_fmac_f32 v75, v70, v60
  v_fmac_f32 v75, v71, v64
  v_rcp_f32 v76, v75
  v_cmp_eq_u32 vcc, 48, v0
  v_mul_f32 v68, v68, v76
  v_mul_f32 v69, v69, v76
  v_mul_f32 v70, v70, v76
  v_mul_f32 v71, v71, v76
  s_waitcnt lgkmcnt(0)
  v_add_f32 v16, v16, v20
  v_add_f32 v17, v17, v21
  v_add_f32 v18, v18, v22
  v_add_f32 v19, v19, v23
  v_add_f32 v24, v24, v28
  v_add_f32 v25, v25, v29
  v_add_f32 v26, v26, v30
  v_add_f32 v27, v27, v31
  v_add_f32 v32, v32, v36
  v_add_f32 v33, v33, v37
  v_add_f32 v34, v34, v38
  v_add_f32 v35, v35, v39
  v_add_f32 v40, v40, v44
  v_add_f32 v41, v41, v45
  v_add_f32 v42, v42, v46
  v_add_f32 v43, v43, v47
  v_mul_f32 v16, v16, v68
  v_mul_f32 v17, v17, v68
  v_mul_f32 v18, v18, v68
  v_mul_f32 v19, v19, v68
  v_fmac_f32 v16, v24, v69
  v_fmac_f32 v17, v25, v69
  v_fmac_f32 v18, v26, v69
  v_fmac_f32 v19, v27, v69
  v_fmac_f32 v16, v32, v70
  v_fmac_f32 v17, v33, v70
  v_fmac_f32 v18, v34, v70
  v_fmac_f32 v19, v35, v70
  v_fmac_f32 v16, v40, v71
  v_fmac_f32 v17, v41, v71
  v_fmac_f32 v18, v42, v71
  v_fmac_f32 v19, v43, v71
  v_cvt_pk_bf16_f32 v78, v16, v17
  v_cvt_pk_bf16_f32 v79, v18, v19
  v_cndmask_b32 v78, v78, v74, vcc
  v_cndmask_b32 v79, v79, v75, vcc
  v_min_u32 v78, -2, v78
  v_min_u32 v79, -2, v79
  s_cmp_eq_u32 s69, 7
  s_cbranch_scc1 L_M_last
  v_cmp_eq_u32 vcc, s69, v0
  v_mov_b32 v101, v99
  v_mov_b32 v100, v98
  v_mov_b32 v99, v97
  v_mov_b32 v98, v96
  v_mov_b32 v97, v95
  v_mov_b32 v96, v94
  v_mov_b32 v95, v93
  v_mov_b32 v94, v92
  v_mov_b32 v93, v91
  v_mov_b32 v92, v90
  v_mov_b32 v91, v89
  v_mov_b32 v90, v88
  v_mov_b32 v88, v78
  v_mov_b32 v89, v79
  v_cndmask_b32 v84, v84, v74, vcc
  v_cndmask_b32 v85, v85, v75, vcc
L_M_next:
  v_add_u32 v80, 6272, v80
  v_add_u32 v81, 6272, v81
  s_add_u32 s69, s69, 1
  s_branch L_merge
L_M_last:
  buffer_store_dwordx2 v[78:79], v82, s[52:55], s77 offen sc1
  s_endpgm
L_X:
  v_mov_b32 v5, 0
  s_waitcnt lgkmcnt(0)
  s_mov_b32 s52, s40
  s_mov_b32 s53, s41
  s_mov_b32 s54, 2150400
  s_mov_b32 s55, 0x00020000
  s_mov_b32 s64, s16
  s_mov_b32 s65, s17
  s_mov_b32 s66, 5120
  s_mov_b32 s67, 0x00020000
  s_barrier
  ds_read_b32 v1, v5 offset:0
  s_sub_u32 s73, s100, 16
  s_cmp_lt_u32 s73, 16
  s_cselect_b32 s73, s73, s7
  v_mov_b32 v6, s73
  v_mov_b32 v7, s7
  v_cmp_gt_u32 vcc, 16, v0
  v_and_b32 v4, 1, v0
  v_lshlrev_b32 v4, 4, v4
  v_cndmask_b32 v6, v6, v7, vcc
  v_and_b32 v7, 14, v0
  v_sub_u32 v6, v6, v7
  v_and_b32 v6, 15, v6
  v_add_u32 v6, v6, v4
  v_bfe_u32 v4, v0, 1, 3
  v_lshl_add_u32 v6, v6, 3, v4
  v_lshlrev_b32 v6, 5, v6
  s_waitcnt lgkmcnt(0)
  s_mov_b32 s81, 262144
  s_mov_b32 exec_lo, 0xffffffff
  s_mov_b32 exec_hi, 0x0
  s_mov_b32 s75, 4096
L_pg:
  buffer_load_dword v15, v6, s[52:55], s75 offen sc1
  s_waitcnt vmcnt(0)
  v_cmp_ne_u32 vcc, v15, v1
  s_cbranch_vccz L_pg_ok
  s_sleep 32
  s_sub_u32 s81, s81, 1
  s_cmp_lg_u32 s81, 0
  s_cbranch_scc1 L_pg
L_pg_ok:
  s_mov_b64 exec, -1
  v_mov_b32 v7, 1
  s_cmp_lt_u32 s4, 20
  s_cbranch_scc0 L_X_notO
  s_mov_b32 s56, s24
  s_mov_b32 s57, s25
  s_mov_b32 s58, 7864320
  s_mov_b32 s59, 0x00020000
  v_lshrrev_b32 v7, 4, v0
  v_mul_u32_u24 v7, 10240, v7
  v_and_b32 v12, 15, v0
  v_lshl_add_u32 v7, v12, 4, v7
  s_mul_i32 s73, s100, 245760
  s_lshl_b32 s74, s101, 8
  s_add_u32 s73, s73, s74
  buffer_load_dwordx4 v[64:67], v7, s[56:59], s73 offen nt
  s_add_u32 s73, s73, 1280
  buffer_load_dwordx4 v[68:71], v7, s[56:59], s73 offen nt
  s_add_u32 s73, s73, 1280
  buffer_load_dwordx4 v[72:75], v7, s[56:59], s73 offen nt
  s_add_u32 s73, s73, 1280
  buffer_load_dwordx4 v[76:79], v7, s[56:59], s73 offen nt
  s_add_u32 s73, s73, 1280
  buffer_load_dwordx4 v[160:163], v7, s[56:59], s73 offen nt
  s_add_u32 s73, s73, 1280
  buffer_load_dwordx4 v[164:167], v7, s[56:59], s73 offen nt
  s_add_u32 s73, s73, 1280
  buffer_load_dwordx4 v[168:171], v7, s[56:59], s73 offen nt
  s_add_u32 s73, s73, 1280
  buffer_load_dwordx4 v[172:175], v7, s[56:59], s73 offen nt
  s_add_u32 s73, s73, 32000
  buffer_load_dwordx4 v[80:83], v7, s[56:59], s73 offen nt
  s_add_u32 s73, s73, 1280
  buffer_load_dwordx4 v[84:87], v7, s[56:59], s73 offen nt
  s_add_u32 s73, s73, 1280
  buffer_load_dwordx4 v[88:91], v7, s[56:59], s73 offen nt
  s_add_u32 s73, s73, 1280
  buffer_load_dwordx4 v[92:95], v7, s[56:59], s73 offen nt
  s_add_u32 s73, s73, 1280
  buffer_load_dwordx4 v[176:179], v7, s[56:59], s73 offen nt
  s_add_u32 s73, s73, 1280
  buffer_load_dwordx4 v[180:183], v7, s[56:59], s73 offen nt
  s_add_u32 s73, s73, 1280
  buffer_load_dwordx4 v[184:187], v7, s[56:59], s73 offen nt
  s_add_u32 s73, s73, 1280
  buffer_load_dwordx4 v[188:191], v7, s[56:59], s73 offen nt
  s_add_u32 s73, s73, 32000
  buffer_load_dwordx4 v[96:99], v7, s[56:59], s73 offen nt
  s_add_u32 s73, s73, 1280
  buffer_load_dwordx4 v[100:103], v7, s[56:59], s73 offen nt
  s_add_u32 s73, s73, 1280
  buffer_load_dwordx4 v[104:107], v7, s[56:59], s73 offen nt
  s_add_u32 s73, s73, 1280
  buffer_load_dwordx4 v[108:111], v7, s[56:59], s73 offen nt
  s_add_u32 s73, s73, 1280
  buffer_load_dwordx4 v[192:195], v7, s[56:59], s73 offen nt
  s_add_u32 s73, s73, 1280
  buffer_load_dwordx4 v[196:199], v7, s[56:59], s73 offen nt
  s_add_u32 s73, s73, 1280
  buffer_load_dwordx4 v[200:203], v7, s[56:59], s73 offen nt
  s_add_u32 s73, s73, 1280
  buffer_load_dwordx4 v[204:207], v7, s[56:59], s73 offen nt
  s_add_u32 s73, s73, 32000
  buffer_load_dwordx4 v[112:115], v7, s[56:59], s73 offen nt
  s_add_u32 s73, s73, 1280
  buffer_load_dwordx4 v[116:119], v7, s[56:59], s73 offen nt
  s_add_u32 s73, s73, 1280
  buffer_load_dwordx4 v[120:123], v7, s[56:59], s73 offen nt
  s_add_u32 s73, s73, 1280
  buffer_load_dwordx4 v[124:127], v7, s[56:59], s73 offen nt
  s_add_u32 s73, s73, 1280
  buffer_load_dwordx4 v[208:211], v7, s[56:59], s73 offen nt
  s_add_u32 s73, s73, 1280
  buffer_load_dwordx4 v[212:215], v7, s[56:59], s73 offen nt
  s_add_u32 s73, s73, 1280
  buffer_load_dwordx4 v[216:219], v7, s[56:59], s73 offen nt
  s_add_u32 s73, s73, 1280
  buffer_load_dwordx4 v[220:223], v7, s[56:59], s73 offen nt
  s_add_u32 s73, s73, 32000
  buffer_load_dwordx4 v[128:131], v7, s[56:59], s73 offen nt
  s_add_u32 s73, s73, 1280
  buffer_load_dwordx4 v[132:135], v7, s[56:59], s73 offen nt
  s_add_u32 s73, s73, 1280
  buffer_load_dwordx4 v[136:139], v7, s[56:59], s73 offen nt
  s_add_u32 s73, s73, 1280
  buffer_load_dwordx4 v[140:143], v7, s[56:59], s73 offen nt
  s_add_u32 s73, s73, 1280
  buffer_load_dwordx4 v[224:227], v7, s[56:59], s73 offen nt
  s_add_u32 s73, s73, 1280
  buffer_load_dwordx4 v[228:231], v7, s[56:59], s73 offen nt
  s_add_u32 s73, s73, 1280
  buffer_load_dwordx4 v[232:235], v7, s[56:59], s73 offen nt
  s_add_u32 s73, s73, 1280
  buffer_load_dwordx4 v[236:239], v7, s[56:59], s73 offen nt
  s_add_u32 s73, s73, 32000
  buffer_load_dwordx4 v[144:147], v7, s[56:59], s73 offen nt
  s_add_u32 s73, s73, 1280
  buffer_load_dwordx4 v[148:151], v7, s[56:59], s73 offen nt
  s_add_u32 s73, s73, 1280
  buffer_load_dwordx4 v[152:155], v7, s[56:59], s73 offen nt
  s_add_u32 s73, s73, 1280
  buffer_load_dwordx4 v[156:159], v7, s[56:59], s73 offen nt
  s_add_u32 s73, s73, 1280
  buffer_load_dwordx4 v[240:243], v7, s[56:59], s73 offen nt
  s_add_u32 s73, s73, 1280
  buffer_load_dwordx4 v[244:247], v7, s[56:59], s73 offen nt
  s_add_u32 s73, s73, 1280
  buffer_load_dwordx4 v[248:251], v7, s[56:59], s73 offen nt
  s_add_u32 s73, s73, 1280
  buffer_load_dwordx4 v[252:255], v7, s[56:59], s73 offen nt
  s_add_u32 s73, s73, 32000
  s_waitcnt vmcnt(40)
  v_mov_b32 v16, v64
  v_mov_b32 v17, v65
  v_mov_b32 v18, v66
  v_mov_b32 v19, v67
  v_mov_b32 v20, v68
  v_mov_b32 v21, v69
  v_mov_b32 v22, v70
  v_mov_b32 v23, v71
  v_mov_b32 v24, v72
  v_mov_b32 v25, v73
  v_mov_b32 v26, v74
  v_mov_b32 v27, v75
  v_mov_b32 v28, v76
  v_mov_b32 v29, v77
  v_mov_b32 v30, v78
  v_mov_b32 v31, v79
  v_mov_b32 v32, v160
  v_mov_b32 v33, v161
  v_mov_b32 v34, v162
  v_mov_b32 v35, v163
  v_mov_b32 v36, v164
  v_mov_b32 v37, v165
  v_mov_b32 v38, v166
  v_mov_b32 v39, v167
  v_mov_b32 v40, v168
  v_mov_b32 v41, v169
  v_mov_b32 v42, v170
  v_mov_b32 v43, v171
  v_mov_b32 v44, v172
  v_mov_b32 v45, v173
  v_mov_b32 v46, v174
  v_mov_b32 v47, v175
  v_perm_b32 v64, v20, v16, s79
  v_perm_b32 v65, v28, v24, s79
  v_perm_b32 v66, v36, v32, s79
  v_perm_b32 v67, v44, v40, s79
  v_perm_b32 v68, v20, v16, s80
  v_perm_b32 v69, v28, v24, s80
  v_perm_b32 v70, v36, v32, s80
  v_perm_b32 v71, v44, v40, s80
  v_perm_b32 v72, v21, v17, s79
  v_perm_b32 v73, v29, v25, s79
  v_perm_b32 v74, v37, v33, s79
  v_perm_b32 v75, v45, v41, s79
  v_perm_b32 v76, v21, v17, s80
  v_perm_b32 v77, v29, v25, s80
  v_perm_b32 v78, v37, v33, s80
  v_perm_b32 v79, v45, v41, s80
  v_perm_b32 v160, v22, v18, s79
  v_perm_b32 v161, v30, v26, s79
  v_perm_b32 v162, v38, v34, s79
  v_perm_b32 v163, v46, v42, s79
  v_perm_b32 v164, v22, v18, s80
  v_perm_b32 v165, v30, v26, s80
  v_perm_b32 v166, v38, v34, s80
  v_perm_b32 v167, v46, v42, s80
  v_perm_b32 v168, v23, v19, s79
  v_perm_b32 v169, v31, v27, s79
  v_perm_b32 v170, v39, v35, s79
  v_perm_b32 v171, v47, v43, s79
  v_perm_b32 v172, v23, v19, s80
  v_perm_b32 v173, v31, v27, s80
  v_perm_b32 v174, v39, v35, s80
  v_perm_b32 v175, v47, v43, s80
  s_waitcnt vmcnt(32)
  v_mov_b32 v16, v80
  v_mov_b32 v17, v81
  v_mov_b32 v18, v82
  v_mov_b32 v19, v83
  v_mov_b32 v20, v84
  v_mov_b32 v21, v85
  v_mov_b32 v22, v86
  v_mov_b32 v23, v87
  v_mov_b32 v24, v88
  v_mov_b32 v25, v89
  v_mov_b32 v26, v90
  v_mov_b32 v27, v91
  v_mov_b32 v28, v92
  v_mov_b32 v29, v93
  v_mov_b32 v30, v94
  v_mov_b32 v31, v95
  v_mov_b32 v32, v176
  v_mov_b32 v33, v177
  v_mov_b32 v34, v178
  v_mov_b32 v35, v179
  v_mov_b32 v36, v180
  v_mov_b32 v37, v181
  v_mov_b32 v38, v182
  v_mov_b32 v39, v183
  v_mov_b32 v40, v184
  v_mov_b32 v41, v185
  v_mov_b32 v42, v186
  v_mov_b32 v43, v187
  v_mov_b32 v44, v188
  v_mov_b32 v45, v189
  v_mov_b32 v46, v190
  v_mov_b32 v47, v191
  v_perm_b32 v80, v20, v16, s79
  v_perm_b32 v81, v28, v24, s79
  v_perm_b32 v82, v36, v32, s79
  v_perm_b32 v83, v44, v40, s79
  v_perm_b32 v84, v20, v16, s80
  v_perm_b32 v85, v28, v24, s80
  v_perm_b32 v86, v36, v32, s80
  v_perm_b32 v87, v44, v40, s80
  v_perm_b32 v88, v21, v17, s79
  v_perm_b32 v89, v29, v25, s79
  v_perm_b32 v90, v37, v33, s79
  v_perm_b32 v91, v45, v41, s79
  v_perm_b32 v92, v21, v17, s80
  v_perm_b32 v93, v29, v25, s80
  v_perm_b32 v94, v37, v33, s80
  v_perm_b32 v95, v45, v41, s80
  v_perm_b32 v176, v22, v18, s79
  v_perm_b32 v177, v30, v26, s79
  v_perm_b32 v178, v38, v34, s79
  v_perm_b32 v179, v46, v42, s79
  v_perm_b32 v180, v22, v18, s80
  v_perm_b32 v181, v30, v26, s80
  v_perm_b32 v182, v38, v34, s80
  v_perm_b32 v183, v46, v42, s80
  v_perm_b32 v184, v23, v19, s79
  v_perm_b32 v185, v31, v27, s79
  v_perm_b32 v186, v39, v35, s79
  v_perm_b32 v187, v47, v43, s79
  v_perm_b32 v188, v23, v19, s80
  v_perm_b32 v189, v31, v27, s80
  v_perm_b32 v190, v39, v35, s80
  v_perm_b32 v191, v47, v43, s80
  s_waitcnt vmcnt(24)
  v_mov_b32 v16, v96
  v_mov_b32 v17, v97
  v_mov_b32 v18, v98
  v_mov_b32 v19, v99
  v_mov_b32 v20, v100
  v_mov_b32 v21, v101
  v_mov_b32 v22, v102
  v_mov_b32 v23, v103
  v_mov_b32 v24, v104
  v_mov_b32 v25, v105
  v_mov_b32 v26, v106
  v_mov_b32 v27, v107
  v_mov_b32 v28, v108
  v_mov_b32 v29, v109
  v_mov_b32 v30, v110
  v_mov_b32 v31, v111
  v_mov_b32 v32, v192
  v_mov_b32 v33, v193
  v_mov_b32 v34, v194
  v_mov_b32 v35, v195
  v_mov_b32 v36, v196
  v_mov_b32 v37, v197
  v_mov_b32 v38, v198
  v_mov_b32 v39, v199
  v_mov_b32 v40, v200
  v_mov_b32 v41, v201
  v_mov_b32 v42, v202
  v_mov_b32 v43, v203
  v_mov_b32 v44, v204
  v_mov_b32 v45, v205
  v_mov_b32 v46, v206
  v_mov_b32 v47, v207
  v_perm_b32 v96, v20, v16, s79
  v_perm_b32 v97, v28, v24, s79
  v_perm_b32 v98, v36, v32, s79
  v_perm_b32 v99, v44, v40, s79
  v_perm_b32 v100, v20, v16, s80
  v_perm_b32 v101, v28, v24, s80
  v_perm_b32 v102, v36, v32, s80
  v_perm_b32 v103, v44, v40, s80
  v_perm_b32 v104, v21, v17, s79
  v_perm_b32 v105, v29, v25, s79
  v_perm_b32 v106, v37, v33, s79
  v_perm_b32 v107, v45, v41, s79
  v_perm_b32 v108, v21, v17, s80
  v_perm_b32 v109, v29, v25, s80
  v_perm_b32 v110, v37, v33, s80
  v_perm_b32 v111, v45, v41, s80
  v_perm_b32 v192, v22, v18, s79
  v_perm_b32 v193, v30, v26, s79
  v_perm_b32 v194, v38, v34, s79
  v_perm_b32 v195, v46, v42, s79
  v_perm_b32 v196, v22, v18, s80
  v_perm_b32 v197, v30, v26, s80
  v_perm_b32 v198, v38, v34, s80
  v_perm_b32 v199, v46, v42, s80
  v_perm_b32 v200, v23, v19, s79
  v_perm_b32 v201, v31, v27, s79
  v_perm_b32 v202, v39, v35, s79
  v_perm_b32 v203, v47, v43, s79
  v_perm_b32 v204, v23, v19, s80
  v_perm_b32 v205, v31, v27, s80
  v_perm_b32 v206, v39, v35, s80
  v_perm_b32 v207, v47, v43, s80
  s_waitcnt vmcnt(16)
  v_mov_b32 v16, v112
  v_mov_b32 v17, v113
  v_mov_b32 v18, v114
  v_mov_b32 v19, v115
  v_mov_b32 v20, v116
  v_mov_b32 v21, v117
  v_mov_b32 v22, v118
  v_mov_b32 v23, v119
  v_mov_b32 v24, v120
  v_mov_b32 v25, v121
  v_mov_b32 v26, v122
  v_mov_b32 v27, v123
  v_mov_b32 v28, v124
  v_mov_b32 v29, v125
  v_mov_b32 v30, v126
  v_mov_b32 v31, v127
  v_mov_b32 v32, v208
  v_mov_b32 v33, v209
  v_mov_b32 v34, v210
  v_mov_b32 v35, v211
  v_mov_b32 v36, v212
  v_mov_b32 v37, v213
  v_mov_b32 v38, v214
  v_mov_b32 v39, v215
  v_mov_b32 v40, v216
  v_mov_b32 v41, v217
  v_mov_b32 v42, v218
  v_mov_b32 v43, v219
  v_mov_b32 v44, v220
  v_mov_b32 v45, v221
  v_mov_b32 v46, v222
  v_mov_b32 v47, v223
  v_perm_b32 v112, v20, v16, s79
  v_perm_b32 v113, v28, v24, s79
  v_perm_b32 v114, v36, v32, s79
  v_perm_b32 v115, v44, v40, s79
  v_perm_b32 v116, v20, v16, s80
  v_perm_b32 v117, v28, v24, s80
  v_perm_b32 v118, v36, v32, s80
  v_perm_b32 v119, v44, v40, s80
  v_perm_b32 v120, v21, v17, s79
  v_perm_b32 v121, v29, v25, s79
  v_perm_b32 v122, v37, v33, s79
  v_perm_b32 v123, v45, v41, s79
  v_perm_b32 v124, v21, v17, s80
  v_perm_b32 v125, v29, v25, s80
  v_perm_b32 v126, v37, v33, s80
  v_perm_b32 v127, v45, v41, s80
  v_perm_b32 v208, v22, v18, s79
  v_perm_b32 v209, v30, v26, s79
  v_perm_b32 v210, v38, v34, s79
  v_perm_b32 v211, v46, v42, s79
  v_perm_b32 v212, v22, v18, s80
  v_perm_b32 v213, v30, v26, s80
  v_perm_b32 v214, v38, v34, s80
  v_perm_b32 v215, v46, v42, s80
  v_perm_b32 v216, v23, v19, s79
  v_perm_b32 v217, v31, v27, s79
  v_perm_b32 v218, v39, v35, s79
  v_perm_b32 v219, v47, v43, s79
  v_perm_b32 v220, v23, v19, s80
  v_perm_b32 v221, v31, v27, s80
  v_perm_b32 v222, v39, v35, s80
  v_perm_b32 v223, v47, v43, s80
  s_waitcnt vmcnt(8)
  v_mov_b32 v16, v128
  v_mov_b32 v17, v129
  v_mov_b32 v18, v130
  v_mov_b32 v19, v131
  v_mov_b32 v20, v132
  v_mov_b32 v21, v133
  v_mov_b32 v22, v134
  v_mov_b32 v23, v135
  v_mov_b32 v24, v136
  v_mov_b32 v25, v137
  v_mov_b32 v26, v138
  v_mov_b32 v27, v139
  v_mov_b32 v28, v140
  v_mov_b32 v29, v141
  v_mov_b32 v30, v142
  v_mov_b32 v31, v143
  v_mov_b32 v32, v224
  v_mov_b32 v33, v225
  v_mov_b32 v34, v226
  v_mov_b32 v35, v227
  v_mov_b32 v36, v228
  v_mov_b32 v37, v229
  v_mov_b32 v38, v230
  v_mov_b32 v39, v231
  v_mov_b32 v40, v232
  v_mov_b32 v41, v233
  v_mov_b32 v42, v234
  v_mov_b32 v43, v235
  v_mov_b32 v44, v236
  v_mov_b32 v45, v237
  v_mov_b32 v46, v238
  v_mov_b32 v47, v239
  v_perm_b32 v128, v20, v16, s79
  v_perm_b32 v129, v28, v24, s79
  v_perm_b32 v130, v36, v32, s79
  v_perm_b32 v131, v44, v40, s79
  v_perm_b32 v132, v20, v16, s80
  v_perm_b32 v133, v28, v24, s80
  v_perm_b32 v134, v36, v32, s80
  v_perm_b32 v135, v44, v40, s80
  v_perm_b32 v136, v21, v17, s79
  v_perm_b32 v137, v29, v25, s79
  v_perm_b32 v138, v37, v33, s79
  v_perm_b32 v139, v45, v41, s79
  v_perm_b32 v140, v21, v17, s80
  v_perm_b32 v141, v29, v25, s80
  v_perm_b32 v142, v37, v33, s80
  v_perm_b32 v143, v45, v41, s80
  v_perm_b32 v224, v22, v18, s79
  v_perm_b32 v225, v30, v26, s79
  v_perm_b32 v226, v38, v34, s79
  v_perm_b32 v227, v46, v42, s79
  v_perm_b32 v228, v22, v18, s80
  v_perm_b32 v229, v30, v26, s80
  v_perm_b32 v230, v38, v34, s80
  v_perm_b32 v231, v46, v42, s80
  v_perm_b32 v232, v23, v19, s79
  v_perm_b32 v233, v31, v27, s79
  v_perm_b32 v234, v39, v35, s79
  v_perm_b32 v235, v47, v43, s79
  v_perm_b32 v236, v23, v19, s80
  v_perm_b32 v237, v31, v27, s80
  v_perm_b32 v238, v39, v35, s80
  v_perm_b32 v239, v47, v43, s80
  s_waitcnt vmcnt(0)
  v_mov_b32 v16, v144
  v_mov_b32 v17, v145
  v_mov_b32 v18, v146
  v_mov_b32 v19, v147
  v_mov_b32 v20, v148
  v_mov_b32 v21, v149
  v_mov_b32 v22, v150
  v_mov_b32 v23, v151
  v_mov_b32 v24, v152
  v_mov_b32 v25, v153
  v_mov_b32 v26, v154
  v_mov_b32 v27, v155
  v_mov_b32 v28, v156
  v_mov_b32 v29, v157
  v_mov_b32 v30, v158
  v_mov_b32 v31, v159
  v_mov_b32 v32, v240
  v_mov_b32 v33, v241
  v_mov_b32 v34, v242
  v_mov_b32 v35, v243
  v_mov_b32 v36, v244
  v_mov_b32 v37, v245
  v_mov_b32 v38, v246
  v_mov_b32 v39, v247
  v_mov_b32 v40, v248
  v_mov_b32 v41, v249
  v_mov_b32 v42, v250
  v_mov_b32 v43, v251
  v_mov_b32 v44, v252
  v_mov_b32 v45, v253
  v_mov_b32 v46, v254
  v_mov_b32 v47, v255
  v_perm_b32 v144, v20, v16, s79
  v_perm_b32 v145, v28, v24, s79
  v_perm_b32 v146, v36, v32, s79
  v_perm_b32 v147, v44, v40, s79
  v_perm_b32 v148, v20, v16, s80
  v_perm_b32 v149, v28, v24, s80
  v_perm_b32 v150, v36, v32, s80
  v_perm_b32 v151, v44, v40, s80
  v_perm_b32 v152, v21, v17, s79
  v_perm_b32 v153, v29, v25, s79
  v_perm_b32 v154, v37, v33, s79
  v_perm_b32 v155, v45, v41, s79
  v_perm_b32 v156, v21, v17, s80
  v_perm_b32 v157, v29, v25, s80
  v_perm_b32 v158, v37, v33, s80
  v_perm_b32 v159, v45, v41, s80
  v_perm_b32 v240, v22, v18, s79
  v_perm_b32 v241, v30, v26, s79
  v_perm_b32 v242, v38, v34, s79
  v_perm_b32 v243, v46, v42, s79
  v_perm_b32 v244, v22, v18, s80
  v_perm_b32 v245, v30, v26, s80
  v_perm_b32 v246, v38, v34, s80
  v_perm_b32 v247, v46, v42, s80
  v_perm_b32 v248, v23, v19, s79
  v_perm_b32 v249, v31, v27, s79
  v_perm_b32 v250, v39, v35, s79
  v_perm_b32 v251, v47, v43, s79
  v_perm_b32 v252, v23, v19, s80
  v_perm_b32 v253, v31, v27, s80
  v_perm_b32 v254, v39, v35, s80
  v_perm_b32 v255, v47, v43, s80
  s_mov_b32 s13, 3
  v_lshlrev_b32 v2, 4, v0
  s_lshl_b32 s74, s13, 13
  s_add_u32 s74, s74, 4352
  v_add_u32 v13, s74, v2
  v_and_b32 v14, 15, v0
  v_mul_u32_u24 v14, 384, v14
  v_and_b32 v12, 48, v0
  v_add3_u32 v14, v14, v12, s74
  v_lshlrev_b32 v3, 8, v12
  s_and_b32 s77, s100, 1
  s_lshl_b32 s77, s77, 7
  s_add_u32 s77, s77, s5
  s_lshl_b32 s77, s77, 7
  s_add_u32 s77, s77, 20480
  s_add_u32 s78, s77, 64
  s_lshr_b32 s74, s100, 4
  s_lshl_b32 s74, s74, 3
  s_add_u32 s77, s77, s74
  s_lshl_b32 s74, s13, 4
  s_add_u32 s77, s77, s74
  s_lshl_b32 s73, s100, 2
  s_add_u32 s73, s73, s13
  s_mul_i32 s73, s73, 6144
  s_add_u32 s73, s73, 380928
  s_lshl_b32 s76, s101, 17
  s_lshl_b32 s74, s100, 9
  s_add_u32 s76, s76, s74
  s_lshl_b32 s74, s13, 15
  s_add_u32 s76, s76, s74
  s_add_u32 s76, s76, 1298432
  v_and_b32 v6, 8, v0
  v_lshlrev_b32 v6, 11, v6
  v_and_b32 v12, 7, v0
  v_lshl_add_u32 v6, v12, 6, v6
  v_and_b32 v12, 48, v0
  v_add_u32 v6, v6, v12
  v_lshlrev_b32 v7, 4, v0
  v_add_u32 v7, 75264, v7
  ds_write_b128 v7, v[64:67] offset:0
  ds_write_b128 v7, v[68:71] offset:1024
  ds_write_b128 v7, v[72:75] offset:2048
  ds_write_b128 v7, v[76:79] offset:3072
  ds_write_b128 v7, v[80:83] offset:4096
  ds_write_b128 v7, v[84:87] offset:5120
  ds_write_b128 v7, v[88:91] offset:6144
  ds_write_b128 v7, v[92:95] offset:7168
  ds_write_b128 v7, v[96:99] offset:8192
  ds_write_b128 v7, v[100:103] offset:9216
  ds_write_b128 v7, v[104:107] offset:10240
  ds_write_b128 v7, v[108:111] offset:11264
  ds_write_b128 v7, v[112:115] offset:12288
  ds_write_b128 v7, v[116:119] offset:13312
  ds_write_b128 v7, v[120:123] offset:14336
  ds_write_b128 v7, v[124:127] offset:15360
  ds_write_b128 v7, v[128:131] offset:16384
  ds_write_b128 v7, v[132:135] offset:17408
  ds_write_b128 v7, v[136:139] offset:18432
  ds_write_b128 v7, v[140:143] offset:19456
  ds_write_b128 v7, v[144:147] offset:20480
  ds_write_b128 v7, v[148:151] offset:21504
  ds_write_b128 v7, v[152:155] offset:22528
  ds_write_b128 v7, v[156:159] offset:23552
  ds_write_b128 v7, v[160:163] offset:24576
  ds_write_b128 v7, v[164:167] offset:25600
  ds_write_b128 v7, v[168:171] offset:26624
  ds_write_b128 v7, v[172:175] offset:27648
  ds_write_b128 v7, v[176:179] offset:28672
  ds_write_b128 v7, v[180:183] offset:29696
  ds_write_b128 v7, v[184:187] offset:30720
  ds_write_b128 v7, v[188:191] offset:31744
  ds_write_b128 v7, v[192:195] offset:32768
  ds_write_b128 v7, v[196:199] offset:33792
  ds_write_b128 v7, v[200:203] offset:34816
  ds_write_b128 v7, v[204:207] offset:35840
  ds_write_b128 v7, v[208:211] offset:36864
  ds_write_b128 v7, v[212:215] offset:37888
  ds_write_b128 v7, v[216:219] offset:38912
  ds_write_b128 v7, v[220:223] offset:39936
  ds_write_b128 v7, v[224:227] offset:40960
  ds_write_b128 v7, v[228:231] offset:41984
  ds_write_b128 v7, v[232:235] offset:43008
  ds_write_b128 v7, v[236:239] offset:44032
  ds_write_b128 v7, v[240:243] offset:45056
  ds_write_b128 v7, v[244:247] offset:46080
  ds_write_b128 v7, v[248:251] offset:47104
  ds_write_b128 v7, v[252:255] offset:48128
  v_mov_b32 v11, 1
  ds_write_b32 v5, v11 offset:4
  v_lshlrev_b32 v4, 10, v0
  s_mov_b32 s81, 1048576
L_xpub:
  ds_read_b32 v12, v5 offset:16
  s_waitcnt lgkmcnt(0)
  v_readfirstlane_b32 s83, v12
  s_nop 0
  s_cmp_lg_u32 s83, 0
  s_cbranch_scc1 L_xpub_ok
  s_sleep 8
  s_sub_u32 s81, s81, 1
  s_cmp_lg_u32 s81, 0
  s_cbranch_scc1 L_xpub
L_xpub_ok:
  s_mov_b32 s81, 262144
  s_mov_b32 exec_lo, 0xffff
  s_mov_b32 exec_hi, 0x0
  s_mov_b32 s75, s78
L_pa:
  s_sleep 16
  buffer_load_dword v15, v4, s[52:55], s75 offen sc1
  s_waitcnt vmcnt(0)
  v_cmp_ne_u32 vcc, v15, v1
  s_cbranch_vccz L_pa_ok
  s_sub_u32 s81, s81, 1
  s_cmp_lg_u32 s81, 0
  s_cbranch_scc1 L_pa
L_pa_ok:
  s_mov_b64 exec, -1
  ds_write_b32 v5, v11 offset:20
  s_cmp_lt_u32 s100, 16
  s_cbranch_scc0 L_xtail
L_job_dense:
  s_add_u32 s74, s73, 4096
  buffer_load_dwordx4 v[16:19], v2, s[52:55], s73 offen offset:0 sc1
  buffer_load_dwordx4 v[20:23], v2, s[52:55], s73 offen offset:1024 sc1
  buffer_load_dwordx4 v[24:27], v2, s[52:55], s73 offen offset:2048 sc1
  buffer_load_dwordx4 v[28:31], v2, s[52:55], s73 offen offset:3072 sc1
  buffer_load_dwordx4 v[32:35], v2, s[52:55], s74 offen offset:0 sc1
  buffer_load_dwordx4 v[36:39], v2, s[52:55], s74 offen offset:1024 sc1
  buffer_load_dwordx2 v[40:41], v3, s[52:55], s77 offen offset:0 sc1
  buffer_load_dwordx2 v[42:43], v3, s[52:55], s77 offen offset:1024 sc1
  buffer_load_dwordx2 v[44:45], v3, s[52:55], s77 offen offset:2048 sc1
  buffer_load_dwordx2 v[46:47], v3, s[52:55], s77 offen offset:3072 sc1
L_job_wait:
  s_waitcnt vmcnt(4)
  ds_write_b128 v13, v[16:19] offset:0
  ds_write_b128 v13, v[20:23] offset:1024
  ds_write_b128 v13, v[24:27] offset:2048
  ds_write_b128 v13, v[28:31] offset:3072
  ds_write_b128 v13, v[32:35] offset:4096
  ds_write_b128 v13, v[36:39] offset:5120
  ds_read_b128 v[16:19], v14 offset:0
  ds_read_b128 v[20:23], v14 offset:64
  ds_read_b128 v[24:27], v14 offset:128
  ds_read_b128 v[28:31], v14 offset:192
  ds_read_b128 v[32:35], v14 offset:256
  ds_read_b128 v[36:39], v14 offset:320
  s_waitcnt vmcnt(0) lgkmcnt(0)
  s_branch L_job_go
L_xtail:
  s_setprio 3
  s_lshl_b32 s73, s100, 13
  s_add_u32 s73, s73, 1036288
  s_add_u32 s74, s73, 4096
  v_and_b32 v12, 15, v0
  v_mul_u32_u24 v12, 144, v12
  v_add_u32 v14, v14, v12
  v_lshrrev_b32 v12, 5, v0
  v_lshl_add_u32 v13, v12, 4, v13
  v_lshrrev_b32 v3, 4, v0
  v_mul_u32_u24 v3, 2112, v3
  v_add_u32 v3, 28928, v3
  s_mov_b64 s[44:45], -1
  s_mov_b32 s82, 1
  s_mov_b32 s81, 262144
L_pollA:
  s_cmp_lg_u32 s82, 0
  s_cbranch_scc1 L_pA1
  s_mov_b64 exec, 0xffff
  buffer_load_dword v15, v4, s[52:55], s78 offen sc1
L_pA1:
  s_mov_b64 exec, s[44:45]
  s_cbranch_execz L_pA2
  buffer_load_dwordx4 v[16:19], v2, s[52:55], s73 offen offset:0 sc1
  buffer_load_dwordx4 v[20:23], v2, s[52:55], s73 offen offset:1024 sc1
  buffer_load_dwordx4 v[24:27], v2, s[52:55], s73 offen offset:2048 sc1
  buffer_load_dwordx4 v[28:31], v2, s[52:55], s73 offen offset:3072 sc1
  buffer_load_dwordx4 v[32:35], v2, s[52:55], s74 offen offset:0 sc1
  buffer_load_dwordx4 v[36:39], v2, s[52:55], s74 offen offset:1024 sc1
  buffer_load_dwordx4 v[40:43], v2, s[52:55], s74 offen offset:2048 sc1
  buffer_load_dwordx4 v[44:47], v2, s[52:55], s74 offen offset:3072 sc1
L_pA2:
  s_mov_b64 exec, -1
  s_waitcnt vmcnt(0)
  s_cmp_lg_u32 s82, 0
  s_cbranch_scc1 L_pA3
  s_mov_b64 exec, 0xffff
  v_cmp_ne_u32 vcc, v15, v1
  s_mov_b64 exec, -1
  s_cbranch_vccnz L_pA3
  ds_write_b32 v5, v11 offset:20
  s_mov_b32 s82, 1
L_pA3:
  v_max3_u32 v8, v16, v17, v18
  v_max3_u32 v9, v19, v20, v21
  v_max3_u32 v8, v8, v22, v23
  v_max3_u32 v9, v9, v24, v25
  v_max3_u32 v8, v8, v26, v27
  v_max3_u32 v9, v9, v28, v29
  v_max3_u32 v8, v8, v30, v31
  v_max3_u32 v9, v9, v32, v33
  v_max3_u32 v8, v8, v34, v35
  v_max3_u32 v9, v9, v36, v37
  v_max3_u32 v8, v8, v38, v39
  v_max3_u32 v9, v9, v40, v41
  v_max3_u32 v8, v8, v42, v43
  v_max3_u32 v9, v9, v44, v45
  v_max3_u32 v8, v8, v46, v47
  v_max_u32 v8, v8, v9
  v_cmp_eq_u32 vcc, -1, v8
  s_mov_b64 s[44:45], vcc
  s_sub_u32 s81, s81, 1
  s_cbranch_scc1 L_pA4
  s_cbranch_vccnz L_pollA
  s_cmp_eq_u32 s82, 0
  s_cbranch_scc1 L_pollA
L_pA4:
  ds_write_b128 v13, v[16:19] offset:0
  ds_write_b128 v13, v[20:23] offset:1056
  ds_write_b128 v13, v[24:27] offset:2112
  ds_write_b128 v13, v[28:31] offset:3168
  ds_write_b128 v13, v[32:35] offset:4224
  ds_write_b128 v13, v[36:39] offset:5280
  ds_write_b128 v13, v[40:43] offset:6336
  ds_write_b128 v13, v[44:47] offset:7392
  ds_read_b64 v[40:41], v3 offset:384
  ds_read_b64 v[42:43], v3 offset:912
  ds_read_b64 v[44:45], v3 offset:1440
  ds_read_b64 v[46:47], v3 offset:1968
  ds_read_b128 v[16:19], v14 offset:0
  ds_read_b128 v[20:23], v14 offset:64
  ds_read_b128 v[24:27], v14 offset:128
  ds_read_b128 v[28:31], v14 offset:192
  ds_read_b128 v[32:35], v14 offset:256
  ds_read_b128 v[36:39], v14 offset:320
  s_waitcnt lgkmcnt(0)
L_job_go:
  v_mfma_f32_16x16x32_bf16 v[48:51], v[16:19], v[64:67], 0
  v_min3_f32 v12, v40, v42, v44
  v_min_f32 v12, v12, v46
  v_mfma_f32_16x16x32_bf16 v[52:55], v[16:19], v[68:71], 0
  v_mov_b32 v13, v12
  s_nop 1
  v_mfma_f32_16x16x32_bf16 v[56:59], v[16:19], v[72:75], 0
  v_permlane16_swap_b32 v12, v13
  s_nop 1
  v_mfma_f32_16x16x32_bf16 v[60:63], v[16:19], v[76:79], 0
  v_min_f32 v12, v12, v13
  v_mov_b32 v13, v12
  v_mfma_f32_16x16x32_bf16 v[48:51], v[20:23], v[80:83], v[48:51]
  s_nop 1
  v_permlane32_swap_b32 v12, v13
  v_mfma_f32_16x16x32_bf16 v[52:55], v[20:23], v[84:87], v[52:55]
  s_nop 1
  v_min_f32 v12, v12, v13
  v_mfma_f32_16x16x32_bf16 v[56:59], v[20:23], v[88:91], v[56:59]
  v_sub_f32 v8, v12, v40
  v_sub_f32 v9, v12, v42
  v_mfma_f32_16x16x32_bf16 v[60:63], v[20:23], v[92:95], v[60:63]
  v_sub_f32 v10, v12, v44
  v_sub_f32 v11, v12, v46
  v_mfma_f32_16x16x32_bf16 v[48:51], v[24:27], v[96:99], v[48:51]
  v_exp_f32 v8, v8
  v_exp_f32 v9, v9
  v_mfma_f32_16x16x32_bf16 v[52:55], v[24:27], v[100:103], v[52:55]
  v_exp_f32 v10, v10
  v_exp_f32 v11, v11
  v_mfma_f32_16x16x32_bf16 v[56:59], v[24:27], v[104:107], v[56:59]
  s_nop 0
  v_mul_f32 v8, v8, v41
  v_mfma_f32_16x16x32_bf16 v[60:63], v[24:27], v[108:111], v[60:63]
  v_mul_f32 v9, v9, v43
  v_mul_f32 v10, v10, v45
  v_mfma_f32_16x16x32_bf16 v[48:51], v[28:31], v[112:115], v[48:51]
  v_mul_f32 v11, v11, v47
  v_add_f32 v12, v8, v9
  v_mfma_f32_16x16x32_bf16 v[52:55], v[28:31], v[116:119], v[52:55]
  v_add_f32 v13, v10, v11
  v_add_f32 v12, v12, v13
  v_mfma_f32_16x16x32_bf16 v[56:59], v[28:31], v[120:123], v[56:59]
  v_mov_b32 v13, v12
  s_nop 1
  v_mfma_f32_16x16x32_bf16 v[60:63], v[28:31], v[124:127], v[60:63]
  v_permlane16_swap_b32 v12, v13
  s_nop 1
  v_mfma_f32_16x16x32_bf16 v[48:51], v[32:35], v[128:131], v[48:51]
  v_add_f32 v12, v12, v13
  v_mov_b32 v13, v12
  v_mfma_f32_16x16x32_bf16 v[52:55], v[32:35], v[132:135], v[52:55]
  s_nop 1
  v_permlane32_swap_b32 v12, v13
  v_mfma_f32_16x16x32_bf16 v[56:59], v[32:35], v[136:139], v[56:59]
  s_nop 1
  v_add_f32 v12, v12, v13
  v_mfma_f32_16x16x32_bf16 v[60:63], v[32:35], v[140:143], v[60:63]
  v_rcp_f32 v12, v12
  s_nop 0
  v_mfma_f32_16x16x32_bf16 v[48:51], v[36:39], v[144:147], v[48:51]
  v_mul_f32 v8, v8, v12
  v_mul_f32 v9, v9, v12
  v_mfma_f32_16x16x32_bf16 v[52:55], v[36:39], v[148:151], v[52:55]
  v_mul_f32 v10, v10, v12
  v_mul_f32 v11, v11, v12
  v_mfma_f32_16x16x32_bf16 v[56:59], v[36:39], v[152:155], v[56:59]
  v_mfma_f32_16x16x32_bf16 v[60:63], v[36:39], v[156:159], v[60:63]
  v_mfma_f32_16x16x32_bf16 v[64:67], v[16:19], v[160:163], 0
  v_mfma_f32_16x16x32_bf16 v[68:71], v[16:19], v[164:167], 0
  v_mfma_f32_16x16x32_bf16 v[72:75], v[16:19], v[168:171], 0
  v_mfma_f32_16x16x32_bf16 v[76:79], v[16:19], v[172:175], 0
  v_mfma_f32_16x16x32_bf16 v[64:67], v[20:23], v[176:179], v[64:67]
  v_mfma_f32_16x16x32_bf16 v[68:71], v[20:23], v[180:183], v[68:71]
  v_mfma_f32_16x16x32_bf16 v[72:75], v[20:23], v[184:187], v[72:75]
  v_mfma_f32_16x16x32_bf16 v[76:79], v[20:23], v[188:191], v[76:79]
  v_mfma_f32_16x16x32_bf16 v[64:67], v[24:27], v[192:195], v[64:67]
  v_mul_f32 v40, v8, v48
  v_mfma_f32_16x16x32_bf16 v[68:71], v[24:27], v[196:199], v[68:71]
  v_mul_f32 v41, v8, v52
  v_mfma_f32_16x16x32_bf16 v[72:75], v[24:27], v[200:203], v[72:75]
  v_mul_f32 v42, v8, v56
  v_mfma_f32_16x16x32_bf16 v[76:79], v[24:27], v[204:207], v[76:79]
  v_mul_f32 v43, v8, v60
  v_mfma_f32_16x16x32_bf16 v[64:67], v[28:31], v[208:211], v[64:67]
  v_fmac_f32 v40, v9, v49
  v_mfma_f32_16x16x32_bf16 v[68:71], v[28:31], v[212:215], v[68:71]
  v_fmac_f32 v41, v9, v53
  v_mfma_f32_16x16x32_bf16 v[72:75], v[28:31], v[216:219], v[72:75]
  v_fmac_f32 v42, v9, v57
  v_mfma_f32_16x16x32_bf16 v[76:79], v[28:31], v[220:223], v[76:79]
  v_fmac_f32 v43, v9, v61
  v_mfma_f32_16x16x32_bf16 v[64:67], v[32:35], v[224:227], v[64:67]
  v_fmac_f32 v40, v10, v50
  v_mfma_f32_16x16x32_bf16 v[68:71], v[32:35], v[228:231], v[68:71]
  v_fmac_f32 v41, v10, v54
  v_mfma_f32_16x16x32_bf16 v[72:75], v[32:35], v[232:235], v[72:75]
  v_fmac_f32 v42, v10, v58
  v_mfma_f32_16x16x32_bf16 v[76:79], v[32:35], v[236:239], v[76:79]
  v_fmac_f32 v43, v10, v62
  v_mfma_f32_16x16x32_bf16 v[64:67], v[36:39], v[240:243], v[64:67]
  v_fmac_f32 v40, v11, v51
  v_mfma_f32_16x16x32_bf16 v[68:71], v[36:39], v[244:247], v[68:71]
  v_fmac_f32 v41, v11, v55
  v_mfma_f32_16x16x32_bf16 v[72:75], v[36:39], v[248:251], v[72:75]
  v_fmac_f32 v42, v11, v59
  v_mfma_f32_16x16x32_bf16 v[76:79], v[36:39], v[252:255], v[76:79]
  v_fmac_f32 v43, v11, v63
  s_nop 7
  v_mul_f32 v44, v8, v64
  v_mul_f32 v45, v8, v68
  v_mul_f32 v46, v8, v72
  v_mul_f32 v47, v8, v76
  v_fmac_f32 v44, v9, v65
  v_fmac_f32 v45, v9, v69
  v_fmac_f32 v46, v9, v73
  v_fmac_f32 v47, v9, v77
  v_fmac_f32 v44, v10, v66
  v_fmac_f32 v45, v10, v70
  v_fmac_f32 v46, v10, v74
  v_fmac_f32 v47, v10, v78
  v_fmac_f32 v44, v11, v67
  v_fmac_f32 v45, v11, v71
  v_fmac_f32 v46, v11, v75
  v_fmac_f32 v47, v11, v79
  s_nop 1
  v_permlane32_swap_b32 v40, v44
  v_permlane32_swap_b32 v41, v45
  v_permlane32_swap_b32 v42, v46
  v_permlane32_swap_b32 v43, v47
  s_nop 1
  v_add_f32 v40, v40, v44
  v_add_f32 v41, v41, v45
  v_add_f32 v42, v42, v46
  v_add_f32 v43, v43, v47
  s_nop 1
  v_permlane16_swap_b32 v40, v42
  v_permlane16_swap_b32 v41, v43
  s_nop 1
  v_add_f32 v40, v40, v42
  v_add_f32 v41, v41, v43
  v_mov_b32 v42, v1
  v_mov_b32 v43, v1
  buffer_store_dwordx4 v[40:43], v6, s[52:55], s76 offen sc1
  s_branch L_X_done
L_X_notO:
  ds_write_b32 v5, v7 offset:4
  s_cmp_lt_u32 s4, 29
  s_cbranch_scc0 L_X_fin
  s_cmp_lt_u32 s4, 23
  s_cbranch_scc1 L_f2start
  s_sub_u32 s73, s4, 23
  s_cmp_ge_u32 s73, 3
  s_cselect_b32 s77, 1, 0
  s_cselect_b32 s56, s30, s28
  s_cselect_b32 s57, s31, s29
  s_mov_b32 s58, 1966080
  s_mov_b32 s59, 0x00020000
  s_mul_i32 s74, s77, 3
  s_sub_u32 s73, s73, s74
  s_mul_i32 s76, s5, 3
  s_add_u32 s76, s76, s73
  v_bfe_u32 v3, v0, 2, 2
  v_mul_u32_u24 v3, 1280, v3
  v_and_b32 v4, 48, v0
  v_add_u32 v3, v3, v4
  v_bfe_u32 v4, v0, 1, 1
  v_mul_u32_u24 v4, 640, v4
  v_add_u32 v3, v3, v4
  v_lshrrev_b32 v2, 4, v0
  v_mul_u32_u24 v2, 24576, v2
  v_and_b32 v4, 7, v0
  v_lshl_add_u32 v2, v4, 4, v2
  v_bfe_u32 v4, v0, 3, 1
  v_mul_u32_u24 v4, 983040, v4
  v_add_u32 v2, v2, v4
  s_lshl_b32 s73, s76, 7
  s_mov_b32 s74, 0
  v_mov_b32 v16, 0
  v_mov_b32 v17, 0
  v_mov_b32 v18, 0
  v_mov_b32 v19, 0
  v_mov_b32 v20, 0
  v_mov_b32 v21, 0
  v_mov_b32 v22, 0
  v_mov_b32 v23, 0
  v_mov_b32 v24, 0
  v_mov_b32 v25, 0
  v_mov_b32 v26, 0
  v_mov_b32 v27, 0
  v_mov_b32 v28, 0
  v_mov_b32 v29, 0
  v_mov_b32 v30, 0
  v_mov_b32 v31, 0
  v_mov_b32 v32, 0
  v_mov_b32 v33, 0
  v_mov_b32 v34, 0
  v_mov_b32 v35, 0
  v_mov_b32 v36, 0
  v_mov_b32 v37, 0
  v_mov_b32 v38, 0
  v_mov_b32 v39, 0
  v_mov_b32 v40, 0
  v_mov_b32 v41, 0
  v_mov_b32 v42, 0
  v_mov_b32 v43, 0
  v_mov_b32 v44, 0
  v_mov_b32 v45, 0
  v_mov_b32 v46, 0
  v_mov_b32 v47, 0
  s_mov_b32 s69, 2
L_f1:
  buffer_load_dwordx4 v[64:67], v3, s[64:67], s74 offen offset:0
  buffer_load_dwordx4 v[68:71], v3, s[64:67], s74 offen offset:64
  buffer_load_dwordx4 v[72:75], v3, s[64:67], s74 offen offset:128
  buffer_load_dwordx4 v[76:79], v3, s[64:67], s74 offen offset:192
  buffer_load_dwordx4 v[80:83], v3, s[64:67], s74 offen offset:256
  s_add_u32 s74, s74, 320
  buffer_load_dwordx4 v[84:87], v2, s[56:59], s73 offen nt
  s_add_u32 s73, s73, 3072
  buffer_load_dwordx4 v[88:91], v2, s[56:59], s73 offen nt
  s_add_u32 s73, s73, 3072
  buffer_load_dwordx4 v[92:95], v2, s[56:59], s73 offen nt
  s_add_u32 s73, s73, 3072
  buffer_load_dwordx4 v[96:99], v2, s[56:59], s73 offen nt
  s_add_u32 s73, s73, 3072
  buffer_load_dwordx4 v[100:103], v2, s[56:59], s73 offen nt
  s_add_u32 s73, s73, 3072
  buffer_load_dwordx4 v[104:107], v2, s[56:59], s73 offen nt
  s_add_u32 s73, s73, 3072
  buffer_load_dwordx4 v[108:111], v2, s[56:59], s73 offen nt
  s_add_u32 s73, s73, 3072
  buffer_load_dwordx4 v[112:115], v2, s[56:59], s73 offen nt
  s_add_u32 s73, s73, 76800
  buffer_load_dwordx4 v[116:119], v2, s[56:59], s73 offen nt
  s_add_u32 s73, s73, 3072
  buffer_load_dwordx4 v[120:123], v2, s[56:59], s73 offen nt
  s_add_u32 s73, s73, 3072
  buffer_load_dwordx4 v[124:127], v2, s[56:59], s73 offen nt
  s_add_u32 s73, s73, 3072
  buffer_load_dwordx4 v[128:131], v2, s[56:59], s73 offen nt
  s_add_u32 s73, s73, 3072
  buffer_load_dwordx4 v[132:135], v2, s[56:59], s73 offen nt
  s_add_u32 s73, s73, 3072
  buffer_load_dwordx4 v[136:139], v2, s[56:59], s73 offen nt
  s_add_u32 s73, s73, 3072
  buffer_load_dwordx4 v[140:143], v2, s[56:59], s73 offen nt
  s_add_u32 s73, s73, 3072
  buffer_load_dwordx4 v[144:147], v2, s[56:59], s73 offen nt
  s_add_u32 s73, s73, 76800
  buffer_load_dwordx4 v[148:151], v2, s[56:59], s73 offen nt
  s_add_u32 s73, s73, 3072
  buffer_load_dwordx4 v[152:155], v2, s[56:59], s73 offen nt
  s_add_u32 s73, s73, 3072
  buffer_load_dwordx4 v[156:159], v2, s[56:59], s73 offen nt
  s_add_u32 s73, s73, 3072
  buffer_load_dwordx4 v[160:163], v2, s[56:59], s73 offen nt
  s_add_u32 s73, s73, 3072
  buffer_load_dwordx4 v[164:167], v2, s[56:59], s73 offen nt
  s_add_u32 s73, s73, 3072
  buffer_load_dwordx4 v[168:171], v2, s[56:59], s73 offen nt
  s_add_u32 s73, s73, 3072
  buffer_load_dwordx4 v[172:175], v2, s[56:59], s73 offen nt
  s_add_u32 s73, s73, 3072
  buffer_load_dwordx4 v[176:179], v2, s[56:59], s73 offen nt
  s_add_u32 s73, s73, 76800
  buffer_load_dwordx4 v[180:183], v2, s[56:59], s73 offen nt
  s_add_u32 s73, s73, 3072
  buffer_load_dwordx4 v[184:187], v2, s[56:59], s73 offen nt
  s_add_u32 s73, s73, 3072
  buffer_load_dwordx4 v[188:191], v2, s[56:59], s73 offen nt
  s_add_u32 s73, s73, 3072
  buffer_load_dwordx4 v[192:195], v2, s[56:59], s73 offen nt
  s_add_u32 s73, s73, 3072
  buffer_load_dwordx4 v[196:199], v2, s[56:59], s73 offen nt
  s_add_u32 s73, s73, 3072
  buffer_load_dwordx4 v[200:203], v2, s[56:59], s73 offen nt
  s_add_u32 s73, s73, 3072
  buffer_load_dwordx4 v[204:207], v2, s[56:59], s73 offen nt
  s_add_u32 s73, s73, 3072
  buffer_load_dwordx4 v[208:211], v2, s[56:59], s73 offen nt
  s_add_u32 s73, s73, 76800
  buffer_load_dwordx4 v[212:215], v2, s[56:59], s73 offen nt
  s_add_u32 s73, s73, 3072
  buffer_load_dwordx4 v[216:219], v2, s[56:59], s73 offen nt
  s_add_u32 s73, s73, 3072
  buffer_load_dwordx4 v[220:223], v2, s[56:59], s73 offen nt
  s_add_u32 s73, s73, 3072
  buffer_load_dwordx4 v[224:227], v2, s[56:59], s73 offen nt
  s_add_u32 s73, s73, 3072
  buffer_load_dwordx4 v[228:231], v2, s[56:59], s73 offen nt
  s_add_u32 s73, s73, 3072
  buffer_load_dwordx4 v[232:235], v2, s[56:59], s73 offen nt
  s_add_u32 s73, s73, 3072
  buffer_load_dwordx4 v[236:239], v2, s[56:59], s73 offen nt
  s_add_u32 s73, s73, 3072
  buffer_load_dwordx4 v[240:243], v2, s[56:59], s73 offen nt
  s_add_u32 s73, s73, 76800
  s_waitcnt vmcnt(32)
  v_perm_b32 v48, v88, v84, s79
  v_perm_b32 v49, v96, v92, s79
  v_perm_b32 v50, v104, v100, s79
  v_perm_b32 v51, v112, v108, s79
  v_perm_b32 v52, v88, v84, s80
  v_perm_b32 v53, v96, v92, s80
  v_perm_b32 v54, v104, v100, s80
  v_perm_b32 v55, v112, v108, s80
  v_perm_b32 v56, v89, v85, s79
  v_perm_b32 v57, v97, v93, s79
  v_perm_b32 v58, v105, v101, s79
  v_perm_b32 v59, v113, v109, s79
  v_perm_b32 v60, v89, v85, s80
  v_perm_b32 v61, v97, v93, s80
  v_perm_b32 v62, v105, v101, s80
  v_perm_b32 v63, v113, v109, s80
  s_nop 1
  v_mfma_f32_16x16x32_bf16 v[16:19], v[64:67], v[48:51], v[16:19]
  v_mfma_f32_16x16x32_bf16 v[20:23], v[64:67], v[52:55], v[20:23]
  v_mfma_f32_16x16x32_bf16 v[24:27], v[64:67], v[56:59], v[24:27]
  v_mfma_f32_16x16x32_bf16 v[28:31], v[64:67], v[60:63], v[28:31]
  v_perm_b32 v48, v90, v86, s79
  v_perm_b32 v49, v98, v94, s79
  v_perm_b32 v50, v106, v102, s79
  v_perm_b32 v51, v114, v110, s79
  v_perm_b32 v52, v90, v86, s80
  v_perm_b32 v53, v98, v94, s80
  v_perm_b32 v54, v106, v102, s80
  v_perm_b32 v55, v114, v110, s80
  v_perm_b32 v56, v91, v87, s79
  v_perm_b32 v57, v99, v95, s79
  v_perm_b32 v58, v107, v103, s79
  v_perm_b32 v59, v115, v111, s79
  v_perm_b32 v60, v91, v87, s80
  v_perm_b32 v61, v99, v95, s80
  v_perm_b32 v62, v107, v103, s80
  v_perm_b32 v63, v115, v111, s80
  s_nop 1
  v_mfma_f32_16x16x32_bf16 v[32:35], v[64:67], v[48:51], v[32:35]
  v_mfma_f32_16x16x32_bf16 v[36:39], v[64:67], v[52:55], v[36:39]
  v_mfma_f32_16x16x32_bf16 v[40:43], v[64:67], v[56:59], v[40:43]
  v_mfma_f32_16x16x32_bf16 v[44:47], v[64:67], v[60:63], v[44:47]
  s_waitcnt vmcnt(24)
  v_perm_b32 v48, v120, v116, s79
  v_perm_b32 v49, v128, v124, s79
  v_perm_b32 v50, v136, v132, s79
  v_perm_b32 v51, v144, v140, s79
  v_perm_b32 v52, v120, v116, s80
  v_perm_b32 v53, v128, v124, s80
  v_perm_b32 v54, v136, v132, s80
  v_perm_b32 v55, v144, v140, s80
  v_perm_b32 v56, v121, v117, s79
  v_perm_b32 v57, v129, v125, s79
  v_perm_b32 v58, v137, v133, s79
  v_perm_b32 v59, v145, v141, s79
  v_perm_b32 v60, v121, v117, s80
  v_perm_b32 v61, v129, v125, s80
  v_perm_b32 v62, v137, v133, s80
  v_perm_b32 v63, v145, v141, s80
  s_nop 1
  v_mfma_f32_16x16x32_bf16 v[16:19], v[68:71], v[48:51], v[16:19]
  v_mfma_f32_16x16x32_bf16 v[20:23], v[68:71], v[52:55], v[20:23]
  v_mfma_f32_16x16x32_bf16 v[24:27], v[68:71], v[56:59], v[24:27]
  v_mfma_f32_16x16x32_bf16 v[28:31], v[68:71], v[60:63], v[28:31]
  v_perm_b32 v48, v122, v118, s79
  v_perm_b32 v49, v130, v126, s79
  v_perm_b32 v50, v138, v134, s79
  v_perm_b32 v51, v146, v142, s79
  v_perm_b32 v52, v122, v118, s80
  v_perm_b32 v53, v130, v126, s80
  v_perm_b32 v54, v138, v134, s80
  v_perm_b32 v55, v146, v142, s80
  v_perm_b32 v56, v123, v119, s79
  v_perm_b32 v57, v131, v127, s79
  v_perm_b32 v58, v139, v135, s79
  v_perm_b32 v59, v147, v143, s79
  v_perm_b32 v60, v123, v119, s80
  v_perm_b32 v61, v131, v127, s80
  v_perm_b32 v62, v139, v135, s80
  v_perm_b32 v63, v147, v143, s80
  s_nop 1
  v_mfma_f32_16x16x32_bf16 v[32:35], v[68:71], v[48:51], v[32:35]
  v_mfma_f32_16x16x32_bf16 v[36:39], v[68:71], v[52:55], v[36:39]
  v_mfma_f32_16x16x32_bf16 v[40:43], v[68:71], v[56:59], v[40:43]
  v_mfma_f32_16x16x32_bf16 v[44:47], v[68:71], v[60:63], v[44:47]
  s_waitcnt vmcnt(16)
  v_perm_b32 v48, v152, v148, s79
  v_perm_b32 v49, v160, v156, s79
  v_perm_b32 v50, v168, v164, s79
  v_perm_b32 v51, v176, v172, s79
  v_perm_b32 v52, v152, v148, s80
  v_perm_b32 v53, v160, v156, s80
  v_perm_b32 v54, v168, v164, s80
  v_perm_b32 v55, v176, v172, s80
  v_perm_b32 v56, v153, v149, s79
  v_perm_b32 v57, v161, v157, s79
  v_perm_b32 v58, v169, v165, s79
  v_perm_b32 v59, v177, v173, s79
  v_perm_b32 v60, v153, v149, s80
  v_perm_b32 v61, v161, v157, s80
  v_perm_b32 v62, v169, v165, s80
  v_perm_b32 v63, v177, v173, s80
  s_nop 1
  v_mfma_f32_16x16x32_bf16 v[16:19], v[72:75], v[48:51], v[16:19]
  v_mfma_f32_16x16x32_bf16 v[20:23], v[72:75], v[52:55], v[20:23]
  v_mfma_f32_16x16x32_bf16 v[24:27], v[72:75], v[56:59], v[24:27]
  v_mfma_f32_16x16x32_bf16 v[28:31], v[72:75], v[60:63], v[28:31]
  v_perm_b32 v48, v154, v150, s79
  v_perm_b32 v49, v162, v158, s79
  v_perm_b32 v50, v170, v166, s79
  v_perm_b32 v51, v178, v174, s79
  v_perm_b32 v52, v154, v150, s80
  v_perm_b32 v53, v162, v158, s80
  v_perm_b32 v54, v170, v166, s80
  v_perm_b32 v55, v178, v174, s80
  v_perm_b32 v56, v155, v151, s79
  v_perm_b32 v57, v163, v159, s79
  v_perm_b32 v58, v171, v167, s79
  v_perm_b32 v59, v179, v175, s79
  v_perm_b32 v60, v155, v151, s80
  v_perm_b32 v61, v163, v159, s80
  v_perm_b32 v62, v171, v167, s80
  v_perm_b32 v63, v179, v175, s80
  s_nop 1
  v_mfma_f32_16x16x32_bf16 v[32:35], v[72:75], v[48:51], v[32:35]
  v_mfma_f32_16x16x32_bf16 v[36:39], v[72:75], v[52:55], v[36:39]
  v_mfma_f32_16x16x32_bf16 v[40:43], v[72:75], v[56:59], v[40:43]
  v_mfma_f32_16x16x32_bf16 v[44:47], v[72:75], v[60:63], v[44:47]
  s_waitcnt vmcnt(8)
  v_perm_b32 v48, v184, v180, s79
  v_perm_b32 v49, v192, v188, s79
  v_perm_b32 v50, v200, v196, s79
  v_perm_b32 v51, v208, v204, s79
  v_perm_b32 v52, v184, v180, s80
  v_perm_b32 v53, v192, v188, s80
  v_perm_b32 v54, v200, v196, s80
  v_perm_b32 v55, v208, v204, s80
  v_perm_b32 v56, v185, v181, s79
  v_perm_b32 v57, v193, v189, s79
  v_perm_b32 v58, v201, v197, s79
  v_perm_b32 v59, v209, v205, s79
  v_perm_b32 v60, v185, v181, s80
  v_perm_b32 v61, v193, v189, s80
  v_perm_b32 v62, v201, v197, s80
  v_perm_b32 v63, v209, v205, s80
  s_nop 1
  v_mfma_f32_16x16x32_bf16 v[16:19], v[76:79], v[48:51], v[16:19]
  v_mfma_f32_16x16x32_bf16 v[20:23], v[76:79], v[52:55], v[20:23]
  v_mfma_f32_16x16x32_bf16 v[24:27], v[76:79], v[56:59], v[24:27]
  v_mfma_f32_16x16x32_bf16 v[28:31], v[76:79], v[60:63], v[28:31]
  v_perm_b32 v48, v186, v182, s79
  v_perm_b32 v49, v194, v190, s79
  v_perm_b32 v50, v202, v198, s79
  v_perm_b32 v51, v210, v206, s79
  v_perm_b32 v52, v186, v182, s80
  v_perm_b32 v53, v194, v190, s80
  v_perm_b32 v54, v202, v198, s80
  v_perm_b32 v55, v210, v206, s80
  v_perm_b32 v56, v187, v183, s79
  v_perm_b32 v57, v195, v191, s79
  v_perm_b32 v58, v203, v199, s79
  v_perm_b32 v59, v211, v207, s79
  v_perm_b32 v60, v187, v183, s80
  v_perm_b32 v61, v195, v191, s80
  v_perm_b32 v62, v203, v199, s80
  v_perm_b32 v63, v211, v207, s80
  s_nop 1
  v_mfma_f32_16x16x32_bf16 v[32:35], v[76:79], v[48:51], v[32:35]
  v_mfma_f32_16x16x32_bf16 v[36:39], v[76:79], v[52:55], v[36:39]
  v_mfma_f32_16x16x32_bf16 v[40:43], v[76:79], v[56:59], v[40:43]
  v_mfma_f32_16x16x32_bf16 v[44:47], v[76:79], v[60:63], v[44:47]
  s_waitcnt vmcnt(0)
  v_perm_b32 v48, v216, v212, s79
  v_perm_b32 v49, v224, v220, s79
  v_perm_b32 v50, v232, v228, s79
  v_perm_b32 v51, v240, v236, s79
  v_perm_b32 v52, v216, v212, s80
  v_perm_b32 v53, v224, v220, s80
  v_perm_b32 v54, v232, v228, s80
  v_perm_b32 v55, v240, v236, s80
  v_perm_b32 v56, v217, v213, s79
  v_perm_b32 v57, v225, v221, s79
  v_perm_b32 v58, v233, v229, s79
  v_perm_b32 v59, v241, v237, s79
  v_perm_b32 v60, v217, v213, s80
  v_perm_b32 v61, v225, v221, s80
  v_perm_b32 v62, v233, v229, s80
  v_perm_b32 v63, v241, v237, s80
  s_nop 1
  v_mfma_f32_16x16x32_bf16 v[16:19], v[80:83], v[48:51], v[16:19]
  v_mfma_f32_16x16x32_bf16 v[20:23], v[80:83], v[52:55], v[20:23]
  v_mfma_f32_16x16x32_bf16 v[24:27], v[80:83], v[56:59], v[24:27]
  v_mfma_f32_16x16x32_bf16 v[28:31], v[80:83], v[60:63], v[28:31]
  v_perm_b32 v48, v218, v214, s79
  v_perm_b32 v49, v226, v222, s79
  v_perm_b32 v50, v234, v230, s79
  v_perm_b32 v51, v242, v238, s79
  v_perm_b32 v52, v218, v214, s80
  v_perm_b32 v53, v226, v222, s80
  v_perm_b32 v54, v234, v230, s80
  v_perm_b32 v55, v242, v238, s80
  v_perm_b32 v56, v219, v215, s79
  v_perm_b32 v57, v227, v223, s79
  v_perm_b32 v58, v235, v231, s79
  v_perm_b32 v59, v243, v239, s79
  v_perm_b32 v60, v219, v215, s80
  v_perm_b32 v61, v227, v223, s80
  v_perm_b32 v62, v235, v231, s80
  v_perm_b32 v63, v243, v239, s80
  s_nop 1
  v_mfma_f32_16x16x32_bf16 v[32:35], v[80:83], v[48:51], v[32:35]
  v_mfma_f32_16x16x32_bf16 v[36:39], v[80:83], v[52:55], v[36:39]
  v_mfma_f32_16x16x32_bf16 v[40:43], v[80:83], v[56:59], v[40:43]
  v_mfma_f32_16x16x32_bf16 v[44:47], v[80:83], v[60:63], v[44:47]
  s_sub_u32 s69, s69, 1
  s_cmp_lg_u32 s69, 0
  s_cbranch_scc1 L_f1
  v_and_b32 v4, 8, v0
  v_cmp_eq_u32 vcc, 0, v4
  s_nop 6
  v_cndmask_b32 v48, v18, v16, vcc
  v_cndmask_b32 v49, v22, v20, vcc
  v_cndmask_b32 v50, v26, v24, vcc
  v_cndmask_b32 v51, v30, v28, vcc
  v_cndmask_b32 v52, v34, v32, vcc
  v_cndmask_b32 v53, v38, v36, vcc
  v_cndmask_b32 v54, v42, v40, vcc
  v_cndmask_b32 v55, v46, v44, vcc
  v_add_f32_dpp v48, v48, v48 row_ror:8 row_mask:0xf bank_mask:0xf
  v_add_f32_dpp v49, v49, v49 row_ror:8 row_mask:0xf bank_mask:0xf
  v_add_f32_dpp v50, v50, v50 row_ror:8 row_mask:0xf bank_mask:0xf
  v_add_f32_dpp v51, v51, v51 row_ror:8 row_mask:0xf bank_mask:0xf
  v_add_f32_dpp v52, v52, v52 row_ror:8 row_mask:0xf bank_mask:0xf
  v_add_f32_dpp v53, v53, v53 row_ror:8 row_mask:0xf bank_mask:0xf
  v_add_f32_dpp v54, v54, v54 row_ror:8 row_mask:0xf bank_mask:0xf
  v_add_f32_dpp v55, v55, v55 row_ror:8 row_mask:0xf bank_mask:0xf
  v_cvt_pk_bf16_f32 v56, v48, v49
  v_cvt_pk_bf16_f32 v57, v50, v51
  v_cvt_pk_bf16_f32 v58, v52, v53
  v_cvt_pk_bf16_f32 v59, v54, v55
  v_lshrrev_b32 v6, 4, v0
  v_lshlrev_b32 v6, 7, v6
  v_and_b32 v4, 7, v0
  v_lshl_add_u32 v6, v4, 4, v6
  s_lshl_b32 s73, s76, 1
  s_add_u32 s73, s73, s77
  s_lshl_b32 s73, s73, 9
  s_add_u32 s73, s73, 1994752
  s_mov_b32 exec_lo, 0x00ff00ff
  s_mov_b32 exec_hi, 0x00ff00ff
  buffer_store_dwordx4 v[56:59], v6, s[52:55], s73 offen sc1
  s_mov_b64 exec, -1
  s_waitcnt vmcnt(0)
  s_lshl_b32 s75, s2, 5
  s_add_u32 s75, s75, 12288
  s_mov_b64 exec, 1
  buffer_store_dword v1, v5, s[52:55], s75 offen sc1
  s_mov_b64 exec, -1
  s_branch L_X_fin
L_f2start:
  s_mul_i32 s73, s5, 3
  s_add_u32 s73, s73, s4
  s_sub_u32 s73, s73, 20
  s_cmp_ge_u32 s73, 20
  s_cbranch_scc1 L_f2flag
  s_mul_i32 s77, s73, 52
  s_lshr_b32 s77, s77, 8
  s_mul_i32 s74, s77, 5
  s_sub_u32 s76, s73, s74
  v_cmp_lt_u32 vcc, 5, v0
  v_lshlrev_b32 v6, 3, v0
  v_subrev_u32 v7, 47, v6
  v_cndmask_b32 v6, v6, v7, vcc
  s_lshl_b32 s73, s77, 1
  s_add_u32 s73, s73, 184
  v_add_u32 v6, s73, v6
  v_lshlrev_b32 v6, 5, v6
  s_mov_b32 s81, 262144
  s_mov_b32 exec_lo, 0xfff
  s_mov_b32 exec_hi, 0x0
  s_mov_b32 s75, 12288
L_pf1:
  s_sleep 127
  buffer_load_dword v15, v6, s[52:55], s75 offen sc1
  s_waitcnt vmcnt(0)
  v_cmp_ne_u32 vcc, v15, v1
  s_cbranch_vccz L_pf1_ok
  s_sub_u32 s81, s81, 1
  s_cmp_lg_u32 s81, 0
  s_cbranch_scc1 L_pf1
L_pf1_ok:
  s_mov_b64 exec, -1
  s_mov_b32 s56, s32
  s_mov_b32 s57, s33
  s_mov_b32 s58, 1966080
  s_mov_b32 s59, 0x00020000
  v_lshrrev_b32 v2, 4, v0
  v_mul_u32_u24 v2, 10240, v2
  v_and_b32 v4, 15, v0
  v_lshl_add_u32 v2, v4, 4, v2
  v_bfe_u32 v3, v0, 2, 2
  v_lshlrev_b32 v3, 7, v3
  v_and_b32 v6, 48, v0
  v_add_u32 v3, v3, v6
  s_mul_i32 s73, s77, 491520
  s_lshl_b32 s74, s76, 8
  s_add_u32 s73, s73, s74
  s_mul_i32 s74, s77, 6144
  s_add_u32 s74, s74, 1994752
  v_mov_b32 v16, 0
  v_mov_b32 v17, 0
  v_mov_b32 v18, 0
  v_mov_b32 v19, 0
  v_mov_b32 v20, 0
  v_mov_b32 v21, 0
  v_mov_b32 v22, 0
  v_mov_b32 v23, 0
  v_mov_b32 v24, 0
  v_mov_b32 v25, 0
  v_mov_b32 v26, 0
  v_mov_b32 v27, 0
  v_mov_b32 v28, 0
  v_mov_b32 v29, 0
  v_mov_b32 v30, 0
  v_mov_b32 v31, 0
  v_mov_b32 v32, 0
  v_mov_b32 v33, 0
  v_mov_b32 v34, 0
  v_mov_b32 v35, 0
  v_mov_b32 v36, 0
  v_mov_b32 v37, 0
  v_mov_b32 v38, 0
  v_mov_b32 v39, 0
  v_mov_b32 v40, 0
  v_mov_b32 v41, 0
  v_mov_b32 v42, 0
  v_mov_b32 v43, 0
  v_mov_b32 v44, 0
  v_mov_b32 v45, 0
  v_mov_b32 v46, 0
  v_mov_b32 v47, 0
  s_mov_b32 s69, 3
L_f2:
  buffer_load_dwordx4 v[64:67], v3, s[52:55], s74 offen offset:0 sc1
  buffer_load_dwordx4 v[68:71], v3, s[52:55], s74 offen offset:512 sc1
  buffer_load_dwordx4 v[72:75], v3, s[52:55], s74 offen offset:64 sc1
  buffer_load_dwordx4 v[76:79], v3, s[52:55], s74 offen offset:576 sc1
  buffer_load_dwordx4 v[80:83], v3, s[52:55], s74 offen offset:1024 sc1
  buffer_load_dwordx4 v[84:87], v3, s[52:55], s74 offen offset:1536 sc1
  buffer_load_dwordx4 v[88:91], v3, s[52:55], s74 offen offset:1088 sc1
  buffer_load_dwordx4 v[92:95], v3, s[52:55], s74 offen offset:1600 sc1
  s_add_u32 s74, s74, 2048
  buffer_load_dwordx4 v[128:131], v2, s[56:59], s73 offen nt
  s_add_u32 s73, s73, 1280
  buffer_load_dwordx4 v[132:135], v2, s[56:59], s73 offen nt
  s_add_u32 s73, s73, 1280
  buffer_load_dwordx4 v[136:139], v2, s[56:59], s73 offen nt
  s_add_u32 s73, s73, 1280
  buffer_load_dwordx4 v[140:143], v2, s[56:59], s73 offen nt
  s_add_u32 s73, s73, 1280
  buffer_load_dwordx4 v[144:147], v2, s[56:59], s73 offen nt
  s_add_u32 s73, s73, 1280
  buffer_load_dwordx4 v[148:151], v2, s[56:59], s73 offen nt
  s_add_u32 s73, s73, 1280
  buffer_load_dwordx4 v[152:155], v2, s[56:59], s73 offen nt
  s_add_u32 s73, s73, 1280
  buffer_load_dwordx4 v[156:159], v2, s[56:59], s73 offen nt
  s_add_u32 s73, s73, 32000
  buffer_load_dwordx4 v[160:163], v2, s[56:59], s73 offen nt
  s_add_u32 s73, s73, 1280
  buffer_load_dwordx4 v[164:167], v2, s[56:59], s73 offen nt
  s_add_u32 s73, s73, 1280
  buffer_load_dwordx4 v[168:171], v2, s[56:59], s73 offen nt
  s_add_u32 s73, s73, 1280
  buffer_load_dwordx4 v[172:175], v2, s[56:59], s73 offen nt
  s_add_u32 s73, s73, 1280
  buffer_load_dwordx4 v[176:179], v2, s[56:59], s73 offen nt
  s_add_u32 s73, s73, 1280
  buffer_load_dwordx4 v[180:183], v2, s[56:59], s73 offen nt
  s_add_u32 s73, s73, 1280
  buffer_load_dwordx4 v[184:187], v2, s[56:59], s73 offen nt
  s_add_u32 s73, s73, 1280
  buffer_load_dwordx4 v[188:191], v2, s[56:59], s73 offen nt
  s_add_u32 s73, s73, 32000
  buffer_load_dwordx4 v[192:195], v2, s[56:59], s73 offen nt
  s_add_u32 s73, s73, 1280
  buffer_load_dwordx4 v[196:199], v2, s[56:59], s73 offen nt
  s_add_u32 s73, s73, 1280
  buffer_load_dwordx4 v[200:203], v2, s[56:59], s73 offen nt
  s_add_u32 s73, s73, 1280
  buffer_load_dwordx4 v[204:207], v2, s[56:59], s73 offen nt
  s_add_u32 s73, s73, 1280
  buffer_load_dwordx4 v[208:211], v2, s[56:59], s73 offen nt
  s_add_u32 s73, s73, 1280
  buffer_load_dwordx4 v[212:215], v2, s[56:59], s73 offen nt
  s_add_u32 s73, s73, 1280
  buffer_load_dwordx4 v[216:219], v2, s[56:59], s73 offen nt
  s_add_u32 s73, s73, 1280
  buffer_load_dwordx4 v[220:223], v2, s[56:59], s73 offen nt
  s_add_u32 s73, s73, 32000
  buffer_load_dwordx4 v[224:227], v2, s[56:59], s73 offen nt
  s_add_u32 s73, s73, 1280
  buffer_load_dwordx4 v[228:231], v2, s[56:59], s73 offen nt
  s_add_u32 s73, s73, 1280
  buffer_load_dwordx4 v[232:235], v2, s[56:59], s73 offen nt
  s_add_u32 s73, s73, 1280
  buffer_load_dwordx4 v[236:239], v2, s[56:59], s73 offen nt
  s_add_u32 s73, s73, 1280
  buffer_load_dwordx4 v[240:243], v2, s[56:59], s73 offen nt
  s_add_u32 s73, s73, 1280
  buffer_load_dwordx4 v[244:247], v2, s[56:59], s73 offen nt
  s_add_u32 s73, s73, 1280
  buffer_load_dwordx4 v[248:251], v2, s[56:59], s73 offen nt
  s_add_u32 s73, s73, 1280
  buffer_load_dwordx4 v[252:255], v2, s[56:59], s73 offen nt
  s_add_u32 s73, s73, 32000
  s_waitcnt vmcnt(32)
  v_lshlrev_b32 v96, 16, v64
  v_and_b32 v97, 0xffff0000, v64
  v_lshlrev_b32 v104, 16, v68
  v_and_b32 v105, 0xffff0000, v68
  v_lshlrev_b32 v98, 16, v65
  v_and_b32 v99, 0xffff0000, v65
  v_lshlrev_b32 v106, 16, v69
  v_and_b32 v107, 0xffff0000, v69
  v_lshlrev_b32 v100, 16, v66
  v_and_b32 v101, 0xffff0000, v66
  v_lshlrev_b32 v108, 16, v70
  v_and_b32 v109, 0xffff0000, v70
  v_lshlrev_b32 v102, 16, v67
  v_and_b32 v103, 0xffff0000, v67
  v_lshlrev_b32 v110, 16, v71
  v_and_b32 v111, 0xffff0000, v71
  v_mul_f32 v112, s71, v96
  v_sub_f32 v112, 0, v112
  v_mul_f32 v113, s71, v97
  v_sub_f32 v113, 0, v113
  v_mul_f32 v114, s71, v98
  v_sub_f32 v114, 0, v114
  v_mul_f32 v115, s71, v99
  v_sub_f32 v115, 0, v115
  v_mul_f32 v116, s71, v100
  v_sub_f32 v116, 0, v116
  v_mul_f32 v117, s71, v101
  v_sub_f32 v117, 0, v117
  v_mul_f32 v118, s71, v102
  v_sub_f32 v118, 0, v118
  v_mul_f32 v119, s71, v103
  v_sub_f32 v119, 0, v119
  v_exp_f32 v112, v112
  v_exp_f32 v113, v113
  v_exp_f32 v114, v114
  v_exp_f32 v115, v115
  v_exp_f32 v116, v116
  v_exp_f32 v117, v117
  v_exp_f32 v118, v118
  v_exp_f32 v119, v119
  v_add_f32 v112, 1.0, v112
  v_add_f32 v113, 1.0, v113
  v_add_f32 v114, 1.0, v114
  v_add_f32 v115, 1.0, v115
  v_add_f32 v116, 1.0, v116
  v_add_f32 v117, 1.0, v117
  v_add_f32 v118, 1.0, v118
  v_add_f32 v119, 1.0, v119
  v_rcp_f32 v112, v112
  v_rcp_f32 v113, v113
  v_rcp_f32 v114, v114
  v_rcp_f32 v115, v115
  v_rcp_f32 v116, v116
  v_rcp_f32 v117, v117
  v_rcp_f32 v118, v118
  v_rcp_f32 v119, v119
  v_mul_f32 v96, v96, v112
  v_cvt_pk_bf16_f32 v96, v96, v96
  v_lshlrev_b32 v96, 16, v96
  v_mul_f32 v96, v96, v104
  v_mul_f32 v97, v97, v113
  v_cvt_pk_bf16_f32 v97, v97, v97
  v_lshlrev_b32 v97, 16, v97
  v_mul_f32 v97, v97, v105
  v_mul_f32 v98, v98, v114
  v_cvt_pk_bf16_f32 v98, v98, v98
  v_lshlrev_b32 v98, 16, v98
  v_mul_f32 v98, v98, v106
  v_mul_f32 v99, v99, v115
  v_cvt_pk_bf16_f32 v99, v99, v99
  v_lshlrev_b32 v99, 16, v99
  v_mul_f32 v99, v99, v107
  v_mul_f32 v100, v100, v116
  v_cvt_pk_bf16_f32 v100, v100, v100
  v_lshlrev_b32 v100, 16, v100
  v_mul_f32 v100, v100, v108
  v_mul_f32 v101, v101, v117
  v_cvt_pk_bf16_f32 v101, v101, v101
  v_lshlrev_b32 v101, 16, v101
  v_mul_f32 v101, v101, v109
  v_mul_f32 v102, v102, v118
  v_cvt_pk_bf16_f32 v102, v102, v102
  v_lshlrev_b32 v102, 16, v102
  v_mul_f32 v102, v102, v110
  v_mul_f32 v103, v103, v119
  v_cvt_pk_bf16_f32 v103, v103, v103
  v_lshlrev_b32 v103, 16, v103
  v_mul_f32 v103, v103, v111
  v_cvt_pk_bf16_f32 v64, v96, v97
  v_cvt_pk_bf16_f32 v65, v98, v99
  v_cvt_pk_bf16_f32 v66, v100, v101
  v_cvt_pk_bf16_f32 v67, v102, v103
  v_lshlrev_b32 v96, 16, v72
  v_and_b32 v97, 0xffff0000, v72
  v_lshlrev_b32 v104, 16, v76
  v_and_b32 v105, 0xffff0000, v76
  v_lshlrev_b32 v98, 16, v73
  v_and_b32 v99, 0xffff0000, v73
  v_lshlrev_b32 v106, 16, v77
  v_and_b32 v107, 0xffff0000, v77
  v_lshlrev_b32 v100, 16, v74
  v_and_b32 v101, 0xffff0000, v74
  v_lshlrev_b32 v108, 16, v78
  v_and_b32 v109, 0xffff0000, v78
  v_lshlrev_b32 v102, 16, v75
  v_and_b32 v103, 0xffff0000, v75
  v_lshlrev_b32 v110, 16, v79
  v_and_b32 v111, 0xffff0000, v79
  v_mul_f32 v112, s71, v96
  v_sub_f32 v112, 0, v112
  v_mul_f32 v113, s71, v97
  v_sub_f32 v113, 0, v113
  v_mul_f32 v114, s71, v98
  v_sub_f32 v114, 0, v114
  v_mul_f32 v115, s71, v99
  v_sub_f32 v115, 0, v115
  v_mul_f32 v116, s71, v100
  v_sub_f32 v116, 0, v116
  v_mul_f32 v117, s71, v101
  v_sub_f32 v117, 0, v117
  v_mul_f32 v118, s71, v102
  v_sub_f32 v118, 0, v118
  v_mul_f32 v119, s71, v103
  v_sub_f32 v119, 0, v119
  v_exp_f32 v112, v112
  v_exp_f32 v113, v113
  v_exp_f32 v114, v114
  v_exp_f32 v115, v115
  v_exp_f32 v116, v116
  v_exp_f32 v117, v117
  v_exp_f32 v118, v118
  v_exp_f32 v119, v119
  v_add_f32 v112, 1.0, v112
  v_add_f32 v113, 1.0, v113
  v_add_f32 v114, 1.0, v114
  v_add_f32 v115, 1.0, v115
  v_add_f32 v116, 1.0, v116
  v_add_f32 v117, 1.0, v117
  v_add_f32 v118, 1.0, v118
  v_add_f32 v119, 1.0, v119
  v_rcp_f32 v112, v112
  v_rcp_f32 v113, v113
  v_rcp_f32 v114, v114
  v_rcp_f32 v115, v115
  v_rcp_f32 v116, v116
  v_rcp_f32 v117, v117
  v_rcp_f32 v118, v118
  v_rcp_f32 v119, v119
  v_mul_f32 v96, v96, v112
  v_cvt_pk_bf16_f32 v96, v96, v96
  v_lshlrev_b32 v96, 16, v96
  v_mul_f32 v96, v96, v104
  v_mul_f32 v97, v97, v113
  v_cvt_pk_bf16_f32 v97, v97, v97
  v_lshlrev_b32 v97, 16, v97
  v_mul_f32 v97, v97, v105
  v_mul_f32 v98, v98, v114
  v_cvt_pk_bf16_f32 v98, v98, v98
  v_lshlrev_b32 v98, 16, v98
  v_mul_f32 v98, v98, v106
  v_mul_f32 v99, v99, v115
  v_cvt_pk_bf16_f32 v99, v99, v99
  v_lshlrev_b32 v99, 16, v99
  v_mul_f32 v99, v99, v107
  v_mul_f32 v100, v100, v116
  v_cvt_pk_bf16_f32 v100, v100, v100
  v_lshlrev_b32 v100, 16, v100
  v_mul_f32 v100, v100, v108
  v_mul_f32 v101, v101, v117
  v_cvt_pk_bf16_f32 v101, v101, v101
  v_lshlrev_b32 v101, 16, v101
  v_mul_f32 v101, v101, v109
  v_mul_f32 v102, v102, v118
  v_cvt_pk_bf16_f32 v102, v102, v102
  v_lshlrev_b32 v102, 16, v102
  v_mul_f32 v102, v102, v110
  v_mul_f32 v103, v103, v119
  v_cvt_pk_bf16_f32 v103, v103, v103
  v_lshlrev_b32 v103, 16, v103
  v_mul_f32 v103, v103, v111
  v_cvt_pk_bf16_f32 v72, v96, v97
  v_cvt_pk_bf16_f32 v73, v98, v99
  v_cvt_pk_bf16_f32 v74, v100, v101
  v_cvt_pk_bf16_f32 v75, v102, v103
  v_lshlrev_b32 v96, 16, v80
  v_and_b32 v97, 0xffff0000, v80
  v_lshlrev_b32 v104, 16, v84
  v_and_b32 v105, 0xffff0000, v84
  v_lshlrev_b32 v98, 16, v81
  v_and_b32 v99, 0xffff0000, v81
  v_lshlrev_b32 v106, 16, v85
  v_and_b32 v107, 0xffff0000, v85
  v_lshlrev_b32 v100, 16, v82
  v_and_b32 v101, 0xffff0000, v82
  v_lshlrev_b32 v108, 16, v86
  v_and_b32 v109, 0xffff0000, v86
  v_lshlrev_b32 v102, 16, v83
  v_and_b32 v103, 0xffff0000, v83
  v_lshlrev_b32 v110, 16, v87
  v_and_b32 v111, 0xffff0000, v87
  v_mul_f32 v112, s71, v96
  v_sub_f32 v112, 0, v112
  v_mul_f32 v113, s71, v97
  v_sub_f32 v113, 0, v113
  v_mul_f32 v114, s71, v98
  v_sub_f32 v114, 0, v114
  v_mul_f32 v115, s71, v99
  v_sub_f32 v115, 0, v115
  v_mul_f32 v116, s71, v100
  v_sub_f32 v116, 0, v116
  v_mul_f32 v117, s71, v101
  v_sub_f32 v117, 0, v117
  v_mul_f32 v118, s71, v102
  v_sub_f32 v118, 0, v118
  v_mul_f32 v119, s71, v103
  v_sub_f32 v119, 0, v119
  v_exp_f32 v112, v112
  v_exp_f32 v113, v113
  v_exp_f32 v114, v114
  v_exp_f32 v115, v115
  v_exp_f32 v116, v116
  v_exp_f32 v117, v117
  v_exp_f32 v118, v118
  v_exp_f32 v119, v119
  v_add_f32 v112, 1.0, v112
  v_add_f32 v113, 1.0, v113
  v_add_f32 v114, 1.0, v114
  v_add_f32 v115, 1.0, v115
  v_add_f32 v116, 1.0, v116
  v_add_f32 v117, 1.0, v117
  v_add_f32 v118, 1.0, v118
  v_add_f32 v119, 1.0, v119
  v_rcp_f32 v112, v112
  v_rcp_f32 v113, v113
  v_rcp_f32 v114, v114
  v_rcp_f32 v115, v115
  v_rcp_f32 v116, v116
  v_rcp_f32 v117, v117
  v_rcp_f32 v118, v118
  v_rcp_f32 v119, v119
  v_mul_f32 v96, v96, v112
  v_cvt_pk_bf16_f32 v96, v96, v96
  v_lshlrev_b32 v96, 16, v96
  v_mul_f32 v96, v96, v104
  v_mul_f32 v97, v97, v113
  v_cvt_pk_bf16_f32 v97, v97, v97
  v_lshlrev_b32 v97, 16, v97
  v_mul_f32 v97, v97, v105
  v_mul_f32 v98, v98, v114
  v_cvt_pk_bf16_f32 v98, v98, v98
  v_lshlrev_b32 v98, 16, v98
  v_mul_f32 v98, v98, v106
  v_mul_f32 v99, v99, v115
  v_cvt_pk_bf16_f32 v99, v99, v99
  v_lshlrev_b32 v99, 16, v99
  v_mul_f32 v99, v99, v107
  v_mul_f32 v100, v100, v116
  v_cvt_pk_bf16_f32 v100, v100, v100
  v_lshlrev_b32 v100, 16, v100
  v_mul_f32 v100, v100, v108
  v_mul_f32 v101, v101, v117
  v_cvt_pk_bf16_f32 v101, v101, v101
  v_lshlrev_b32 v101, 16, v101
  v_mul_f32 v101, v101, v109
  v_mul_f32 v102, v102, v118
  v_cvt_pk_bf16_f32 v102, v102, v102
  v_lshlrev_b32 v102, 16, v102
  v_mul_f32 v102, v102, v110
  v_mul_f32 v103, v103, v119
  v_cvt_pk_bf16_f32 v103, v103, v103
  v_lshlrev_b32 v103, 16, v103
  v_mul_f32 v103, v103, v111
  v_cvt_pk_bf16_f32 v80, v96, v97
  v_cvt_pk_bf16_f32 v81, v98, v99
  v_cvt_pk_bf16_f32 v82, v100, v101
  v_cvt_pk_bf16_f32 v83, v102, v103
  v_lshlrev_b32 v96, 16, v88
  v_and_b32 v97, 0xffff0000, v88
  v_lshlrev_b32 v104, 16, v92
  v_and_b32 v105, 0xffff0000, v92
  v_lshlrev_b32 v98, 16, v89
  v_and_b32 v99, 0xffff0000, v89
  v_lshlrev_b32 v106, 16, v93
  v_and_b32 v107, 0xffff0000, v93
  v_lshlrev_b32 v100, 16, v90
  v_and_b32 v101, 0xffff0000, v90
  v_lshlrev_b32 v108, 16, v94
  v_and_b32 v109, 0xffff0000, v94
  v_lshlrev_b32 v102, 16, v91
  v_and_b32 v103, 0xffff0000, v91
  v_lshlrev_b32 v110, 16, v95
  v_and_b32 v111, 0xffff0000, v95
  v_mul_f32 v112, s71, v96
  v_sub_f32 v112, 0, v112
  v_mul_f32 v113, s71, v97
  v_sub_f32 v113, 0, v113
  v_mul_f32 v114, s71, v98
  v_sub_f32 v114, 0, v114
  v_mul_f32 v115, s71, v99
  v_sub_f32 v115, 0, v115
  v_mul_f32 v116, s71, v100
  v_sub_f32 v116, 0, v116
  v_mul_f32 v117, s71, v101
  v_sub_f32 v117, 0, v117
  v_mul_f32 v118, s71, v102
  v_sub_f32 v118, 0, v118
  v_mul_f32 v119, s71, v103
  v_sub_f32 v119, 0, v119
  v_exp_f32 v112, v112
  v_exp_f32 v113, v113
  v_exp_f32 v114, v114
  v_exp_f32 v115, v115
  v_exp_f32 v116, v116
  v_exp_f32 v117, v117
  v_exp_f32 v118, v118
  v_exp_f32 v119, v119
  v_add_f32 v112, 1.0, v112
  v_add_f32 v113, 1.0, v113
  v_add_f32 v114, 1.0, v114
  v_add_f32 v115, 1.0, v115
  v_add_f32 v116, 1.0, v116
  v_add_f32 v117, 1.0, v117
  v_add_f32 v118, 1.0, v118
  v_add_f32 v119, 1.0, v119
  v_rcp_f32 v112, v112
  v_rcp_f32 v113, v113
  v_rcp_f32 v114, v114
  v_rcp_f32 v115, v115
  v_rcp_f32 v116, v116
  v_rcp_f32 v117, v117
  v_rcp_f32 v118, v118
  v_rcp_f32 v119, v119
  v_mul_f32 v96, v96, v112
  v_cvt_pk_bf16_f32 v96, v96, v96
  v_lshlrev_b32 v96, 16, v96
  v_mul_f32 v96, v96, v104
  v_mul_f32 v97, v97, v113
  v_cvt_pk_bf16_f32 v97, v97, v97
  v_lshlrev_b32 v97, 16, v97
  v_mul_f32 v97, v97, v105
  v_mul_f32 v98, v98, v114
  v_cvt_pk_bf16_f32 v98, v98, v98
  v_lshlrev_b32 v98, 16, v98
  v_mul_f32 v98, v98, v106
  v_mul_f32 v99, v99, v115
  v_cvt_pk_bf16_f32 v99, v99, v99
  v_lshlrev_b32 v99, 16, v99
  v_mul_f32 v99, v99, v107
  v_mul_f32 v100, v100, v116
  v_cvt_pk_bf16_f32 v100, v100, v100
  v_lshlrev_b32 v100, 16, v100
  v_mul_f32 v100, v100, v108
  v_mul_f32 v101, v101, v117
  v_cvt_pk_bf16_f32 v101, v101, v101
  v_lshlrev_b32 v101, 16, v101
  v_mul_f32 v101, v101, v109
  v_mul_f32 v102, v102, v118
  v_cvt_pk_bf16_f32 v102, v102, v102
  v_lshlrev_b32 v102, 16, v102
  v_mul_f32 v102, v102, v110
  v_mul_f32 v103, v103, v119
  v_cvt_pk_bf16_f32 v103, v103, v103
  v_lshlrev_b32 v103, 16, v103
  v_mul_f32 v103, v103, v111
  v_cvt_pk_bf16_f32 v88, v96, v97
  v_cvt_pk_bf16_f32 v89, v98, v99
  v_cvt_pk_bf16_f32 v90, v100, v101
  v_cvt_pk_bf16_f32 v91, v102, v103
  s_waitcnt vmcnt(24)
  v_perm_b32 v48, v132, v128, s79
  v_perm_b32 v49, v140, v136, s79
  v_perm_b32 v50, v148, v144, s79
  v_perm_b32 v51, v156, v152, s79
  v_perm_b32 v52, v132, v128, s80
  v_perm_b32 v53, v140, v136, s80
  v_perm_b32 v54, v148, v144, s80
  v_perm_b32 v55, v156, v152, s80
  v_perm_b32 v56, v133, v129, s79
  v_perm_b32 v57, v141, v137, s79
  v_perm_b32 v58, v149, v145, s79
  v_perm_b32 v59, v157, v153, s79
  v_perm_b32 v60, v133, v129, s80
  v_perm_b32 v61, v141, v137, s80
  v_perm_b32 v62, v149, v145, s80
  v_perm_b32 v63, v157, v153, s80
  s_nop 1
  v_mfma_f32_16x16x32_bf16 v[16:19], v[64:67], v[48:51], v[16:19]
  v_mfma_f32_16x16x32_bf16 v[20:23], v[64:67], v[52:55], v[20:23]
  v_mfma_f32_16x16x32_bf16 v[24:27], v[64:67], v[56:59], v[24:27]
  v_mfma_f32_16x16x32_bf16 v[28:31], v[64:67], v[60:63], v[28:31]
  v_perm_b32 v48, v134, v130, s79
  v_perm_b32 v49, v142, v138, s79
  v_perm_b32 v50, v150, v146, s79
  v_perm_b32 v51, v158, v154, s79
  v_perm_b32 v52, v134, v130, s80
  v_perm_b32 v53, v142, v138, s80
  v_perm_b32 v54, v150, v146, s80
  v_perm_b32 v55, v158, v154, s80
  v_perm_b32 v56, v135, v131, s79
  v_perm_b32 v57, v143, v139, s79
  v_perm_b32 v58, v151, v147, s79
  v_perm_b32 v59, v159, v155, s79
  v_perm_b32 v60, v135, v131, s80
  v_perm_b32 v61, v143, v139, s80
  v_perm_b32 v62, v151, v147, s80
  v_perm_b32 v63, v159, v155, s80
  s_nop 1
  v_mfma_f32_16x16x32_bf16 v[32:35], v[64:67], v[48:51], v[32:35]
  v_mfma_f32_16x16x32_bf16 v[36:39], v[64:67], v[52:55], v[36:39]
  v_mfma_f32_16x16x32_bf16 v[40:43], v[64:67], v[56:59], v[40:43]
  v_mfma_f32_16x16x32_bf16 v[44:47], v[64:67], v[60:63], v[44:47]
  s_waitcnt vmcnt(16)
  v_perm_b32 v48, v164, v160, s79
  v_perm_b32 v49, v172, v168, s79
  v_perm_b32 v50, v180, v176, s79
  v_perm_b32 v51, v188, v184, s79
  v_perm_b32 v52, v164, v160, s80
  v_perm_b32 v53, v172, v168, s80
  v_perm_b32 v54, v180, v176, s80
  v_perm_b32 v55, v188, v184, s80
  v_perm_b32 v56, v165, v161, s79
  v_perm_b32 v57, v173, v169, s79
  v_perm_b32 v58, v181, v177, s79
  v_perm_b32 v59, v189, v185, s79
  v_perm_b32 v60, v165, v161, s80
  v_perm_b32 v61, v173, v169, s80
  v_perm_b32 v62, v181, v177, s80
  v_perm_b32 v63, v189, v185, s80
  s_nop 1
  v_mfma_f32_16x16x32_bf16 v[16:19], v[72:75], v[48:51], v[16:19]
  v_mfma_f32_16x16x32_bf16 v[20:23], v[72:75], v[52:55], v[20:23]
  v_mfma_f32_16x16x32_bf16 v[24:27], v[72:75], v[56:59], v[24:27]
  v_mfma_f32_16x16x32_bf16 v[28:31], v[72:75], v[60:63], v[28:31]
  v_perm_b32 v48, v166, v162, s79
  v_perm_b32 v49, v174, v170, s79
  v_perm_b32 v50, v182, v178, s79
  v_perm_b32 v51, v190, v186, s79
  v_perm_b32 v52, v166, v162, s80
  v_perm_b32 v53, v174, v170, s80
  v_perm_b32 v54, v182, v178, s80
  v_perm_b32 v55, v190, v186, s80
  v_perm_b32 v56, v167, v163, s79
  v_perm_b32 v57, v175, v171, s79
  v_perm_b32 v58, v183, v179, s79
  v_perm_b32 v59, v191, v187, s79
  v_perm_b32 v60, v167, v163, s80
  v_perm_b32 v61, v175, v171, s80
  v_perm_b32 v62, v183, v179, s80
  v_perm_b32 v63, v191, v187, s80
  s_nop 1
  v_mfma_f32_16x16x32_bf16 v[32:35], v[72:75], v[48:51], v[32:35]
  v_mfma_f32_16x16x32_bf16 v[36:39], v[72:75], v[52:55], v[36:39]
  v_mfma_f32_16x16x32_bf16 v[40:43], v[72:75], v[56:59], v[40:43]
  v_mfma_f32_16x16x32_bf16 v[44:47], v[72:75], v[60:63], v[44:47]
  s_waitcnt vmcnt(8)
  v_perm_b32 v48, v196, v192, s79
  v_perm_b32 v49, v204, v200, s79
  v_perm_b32 v50, v212, v208, s79
  v_perm_b32 v51, v220, v216, s79
  v_perm_b32 v52, v196, v192, s80
  v_perm_b32 v53, v204, v200, s80
  v_perm_b32 v54, v212, v208, s80
  v_perm_b32 v55, v220, v216, s80
  v_perm_b32 v56, v197, v193, s79
  v_perm_b32 v57, v205, v201, s79
  v_perm_b32 v58, v213, v209, s79
  v_perm_b32 v59, v221, v217, s79
  v_perm_b32 v60, v197, v193, s80
  v_perm_b32 v61, v205, v201, s80
  v_perm_b32 v62, v213, v209, s80
  v_perm_b32 v63, v221, v217, s80
  s_nop 1
  v_mfma_f32_16x16x32_bf16 v[16:19], v[80:83], v[48:51], v[16:19]
  v_mfma_f32_16x16x32_bf16 v[20:23], v[80:83], v[52:55], v[20:23]
  v_mfma_f32_16x16x32_bf16 v[24:27], v[80:83], v[56:59], v[24:27]
  v_mfma_f32_16x16x32_bf16 v[28:31], v[80:83], v[60:63], v[28:31]
  v_perm_b32 v48, v198, v194, s79
  v_perm_b32 v49, v206, v202, s79
  v_perm_b32 v50, v214, v210, s79
  v_perm_b32 v51, v222, v218, s79
  v_perm_b32 v52, v198, v194, s80
  v_perm_b32 v53, v206, v202, s80
  v_perm_b32 v54, v214, v210, s80
  v_perm_b32 v55, v222, v218, s80
  v_perm_b32 v56, v199, v195, s79
  v_perm_b32 v57, v207, v203, s79
  v_perm_b32 v58, v215, v211, s79
  v_perm_b32 v59, v223, v219, s79
  v_perm_b32 v60, v199, v195, s80
  v_perm_b32 v61, v207, v203, s80
  v_perm_b32 v62, v215, v211, s80
  v_perm_b32 v63, v223, v219, s80
  s_nop 1
  v_mfma_f32_16x16x32_bf16 v[32:35], v[80:83], v[48:51], v[32:35]
  v_mfma_f32_16x16x32_bf16 v[36:39], v[80:83], v[52:55], v[36:39]
  v_mfma_f32_16x16x32_bf16 v[40:43], v[80:83], v[56:59], v[40:43]
  v_mfma_f32_16x16x32_bf16 v[44:47], v[80:83], v[60:63], v[44:47]
  s_waitcnt vmcnt(0)
  v_perm_b32 v48, v228, v224, s79
  v_perm_b32 v49, v236, v232, s79
  v_perm_b32 v50, v244, v240, s79
  v_perm_b32 v51, v252, v248, s79
  v_perm_b32 v52, v228, v224, s80
  v_perm_b32 v53, v236, v232, s80
  v_perm_b32 v54, v244, v240, s80
  v_perm_b32 v55, v252, v248, s80
  v_perm_b32 v56, v229, v225, s79
  v_perm_b32 v57, v237, v233, s79
  v_perm_b32 v58, v245, v241, s79
  v_perm_b32 v59, v253, v249, s79
  v_perm_b32 v60, v229, v225, s80
  v_perm_b32 v61, v237, v233, s80
  v_perm_b32 v62, v245, v241, s80
  v_perm_b32 v63, v253, v249, s80
  s_nop 1
  v_mfma_f32_16x16x32_bf16 v[16:19], v[88:91], v[48:51], v[16:19]
  v_mfma_f32_16x16x32_bf16 v[20:23], v[88:91], v[52:55], v[20:23]
  v_mfma_f32_16x16x32_bf16 v[24:27], v[88:91], v[56:59], v[24:27]
  v_mfma_f32_16x16x32_bf16 v[28:31], v[88:91], v[60:63], v[28:31]
  v_perm_b32 v48, v230, v226, s79
  v_perm_b32 v49, v238, v234, s79
  v_perm_b32 v50, v246, v242, s79
  v_perm_b32 v51, v254, v250, s79
  v_perm_b32 v52, v230, v226, s80
  v_perm_b32 v53, v238, v234, s80
  v_perm_b32 v54, v246, v242, s80
  v_perm_b32 v55, v254, v250, s80
  v_perm_b32 v56, v231, v227, s79
  v_perm_b32 v57, v239, v235, s79
  v_perm_b32 v58, v247, v243, s79
  v_perm_b32 v59, v255, v251, s79
  v_perm_b32 v60, v231, v227, s80
  v_perm_b32 v61, v239, v235, s80
  v_perm_b32 v62, v247, v243, s80
  v_perm_b32 v63, v255, v251, s80
  s_nop 1
  v_mfma_f32_16x16x32_bf16 v[32:35], v[88:91], v[48:51], v[32:35]
  v_mfma_f32_16x16x32_bf16 v[36:39], v[88:91], v[52:55], v[36:39]
  v_mfma_f32_16x16x32_bf16 v[40:43], v[88:91], v[56:59], v[40:43]
  v_mfma_f32_16x16x32_bf16 v[44:47], v[88:91], v[60:63], v[44:47]
  s_sub_u32 s69, s69, 1
  s_cmp_lg_u32 s69, 0
  s_cbranch_scc1 L_f2
  s_nop 7
  v_mov_b32 v48, v16
  v_mov_b32 v49, v20
  v_mov_b32 v50, v24
  v_mov_b32 v51, v28
  v_mov_b32 v52, v32
  v_mov_b32 v53, v36
  v_mov_b32 v54, v40
  v_mov_b32 v55, v44
  v_lshrrev_b32 v12, 4, v0
  v_mul_u32_u24 v12, 2560, v12
  v_lshl_add_u32 v12, v4, 4, v12
  s_mul_i32 s74, s77, 10240
  s_lshl_b32 s73, s76, 9
  s_add_u32 s74, s74, s73
  s_add_u32 s74, s74, 1953792
  buffer_store_dwordx4 v[48:51], v12, s[52:55], s74 offen sc1
  buffer_store_dwordx4 v[52:55], v12, s[52:55], s74 offen offset:256 sc1
L_f2flag:
  s_waitcnt vmcnt(0)
  s_lshl_b32 s75, s2, 5
  s_add_u32 s75, s75, 12288
  s_mov_b64 exec, 1
  buffer_store_dword v1, v5, s[52:55], s75 offen sc1
  s_mov_b64 exec, -1
  s_branch L_X_done
L_X_fin:
  s_cmp_lt_u32 s4, 27
  s_cbranch_scc1 L_X_done
  s_mul_i32 s78, s5, 5
  s_add_u32 s78, s78, s4
  s_sub_u32 s78, s78, 27
  s_mov_b32 s56, s34
  s_mov_b32 s57, s35
  s_mov_b32 s58, 1280
  s_mov_b32 s59, 0x00020000
  s_mov_b32 s60, s36
  s_mov_b32 s61, s37
  s_mov_b32 s62, 5120
  s_mov_b32 s63, 0x00020000
  s_bfe_u32 s77, s78, 0x20001
  v_lshlrev_b32 v84, 2, v0
  s_mul_i32 s73, s77, 1280
  buffer_load_dword v72, v84, s[64:67], s73 offen offset:0
  buffer_load_dword v77, v84, s[56:59], 0 offen offset:0
  buffer_load_dword v73, v84, s[64:67], s73 offen offset:256
  buffer_load_dword v78, v84, s[56:59], 0 offen offset:256
  buffer_load_dword v74, v84, s[64:67], s73 offen offset:512
  buffer_load_dword v79, v84, s[56:59], 0 offen offset:512
  buffer_load_dword v75, v84, s[64:67], s73 offen offset:768
  buffer_load_dword v80, v84, s[56:59], 0 offen offset:768
  buffer_load_dword v76, v84, s[64:67], s73 offen offset:1024
  buffer_load_dword v81, v84, s[56:59], 0 offen offset:1024
  s_lshr_b32 s76, s78, 3
  s_lshl_b32 s76, s76, 1
  s_and_b32 s74, s78, 1
  s_add_u32 s76, s76, s74
  s_lshl_b32 s76, s76, 6
  s_waitcnt vmcnt(0)
  v_mov_b32 v87, 0
  v_lshlrev_b32 v88, 16, v72
  v_and_b32 v89, 0xffff0000, v72
  v_lshlrev_b32 v90, 16, v77
  v_and_b32 v91, 0xffff0000, v77
  v_mul_f32 v88, v88, v90
  v_mul_f32 v89, v89, v91
  v_cvt_pk_bf16_f32 v88, v88, v89
  v_and_b32 v89, 0xffff0000, v88
  v_lshlrev_b32 v88, 16, v88
  v_add_f32 v87, v87, v88
  v_add_f32 v87, v87, v89
  v_lshlrev_b32 v88, 16, v73
  v_and_b32 v89, 0xffff0000, v73
  v_lshlrev_b32 v90, 16, v78
  v_and_b32 v91, 0xffff0000, v78
  v_mul_f32 v88, v88, v90
  v_mul_f32 v89, v89, v91
  v_cvt_pk_bf16_f32 v88, v88, v89
  v_and_b32 v89, 0xffff0000, v88
  v_lshlrev_b32 v88, 16, v88
  v_add_f32 v87, v87, v88
  v_add_f32 v87, v87, v89
  v_lshlrev_b32 v88, 16, v74
  v_and_b32 v89, 0xffff0000, v74
  v_lshlrev_b32 v90, 16, v79
  v_and_b32 v91, 0xffff0000, v79
  v_mul_f32 v88, v88, v90
  v_mul_f32 v89, v89, v91
  v_cvt_pk_bf16_f32 v88, v88, v89
  v_and_b32 v89, 0xffff0000, v88
  v_lshlrev_b32 v88, 16, v88
  v_add_f32 v87, v87, v88
  v_add_f32 v87, v87, v89
  v_lshlrev_b32 v88, 16, v75
  v_and_b32 v89, 0xffff0000, v75
  v_lshlrev_b32 v90, 16, v80
  v_and_b32 v91, 0xffff0000, v80
  v_mul_f32 v88, v88, v90
  v_mul_f32 v89, v89, v91
  v_cvt_pk_bf16_f32 v88, v88, v89
  v_and_b32 v89, 0xffff0000, v88
  v_lshlrev_b32 v88, 16, v88
  v_add_f32 v87, v87, v88
  v_add_f32 v87, v87, v89
  v_lshlrev_b32 v88, 16, v76
  v_and_b32 v89, 0xffff0000, v76
  v_lshlrev_b32 v90, 16, v81
  v_and_b32 v91, 0xffff0000, v81
  v_mul_f32 v88, v88, v90
  v_mul_f32 v89, v89, v91
  v_cvt_pk_bf16_f32 v88, v88, v89
  v_and_b32 v89, 0xffff0000, v88
  v_lshlrev_b32 v88, 16, v88
  v_add_f32 v87, v87, v88
  v_add_f32 v87, v87, v89
  s_nop 1
  v_add_f32_dpp v87, v87, v87 quad_perm:[1,0,3,2] row_mask:0xf bank_mask:0xf
  s_nop 1
  v_add_f32_dpp v87, v87, v87 quad_perm:[2,3,0,1] row_mask:0xf bank_mask:0xf
  s_nop 1
  v_add_f32_dpp v87, v87, v87 row_half_mirror row_mask:0xf bank_mask:0xf
  s_nop 1
  v_add_f32_dpp v87, v87, v87 row_ror:8 row_mask:0xf bank_mask:0xf
  v_mov_b32 v88, v87
  s_nop 1
  v_permlane16_swap_b32 v87, v88
  s_nop 1
  v_add_f32 v87, v87, v88
  v_mov_b32 v88, v87
  s_nop 1
  v_permlane32_swap_b32 v87, v88
  s_nop 1
  v_add_f32 v87, v87, v88
  v_cvt_pk_bf16_f32 v87, v87, v87
  v_lshlrev_b32 v87, 16, v87
  v_mul_f32 v87, s71, v87
  v_sub_f32 v87, 0, v87
  v_exp_f32 v87, v87
  s_nop 0
  v_add_f32 v87, 1.0, v87
  v_rcp_f32 v87, v87
  s_nop 0
  v_cvt_pk_bf16_f32 v87, v87, v87
  v_lshlrev_b32 v87, 16, v87
  v_sub_f32 v88, 1.0, v87
  v_cvt_pk_bf16_f32 v88, v88, v88
  v_lshlrev_b32 v88, 16, v88
  v_lshlrev_b32 v6, 5, v0
  v_mov_b32 v92, 4352
  s_mov_b32 s81, 1048576
L_fw0:
  ds_read_b32 v93, v92 offset:6224
  s_waitcnt lgkmcnt(0)
  v_readfirstlane_b32 s83, v93
  s_nop 0
  s_cmp_eq_u32 s83, 4
  s_cbranch_scc1 L_fw0_ok
  s_sleep 32
  s_sub_u32 s81, s81, 1
  s_cmp_lg_u32 s81, 0
  s_cbranch_scc1 L_fw0
L_fw0_ok:
  s_mov_b32 s81, 262144
  s_mov_b32 exec_lo, 0xffffff
  s_mov_b32 exec_hi, 0x0
  s_mov_b32 s75, 17408
L_po:
  buffer_load_dword v15, v6, s[52:55], s75 offen sc1
  s_waitcnt vmcnt(0)
  v_cmp_ne_u32 vcc, v15, v1
  s_cbranch_vccz L_po_ok
  s_sleep 32
  s_sub_u32 s81, s81, 1
  s_cmp_lg_u32 s81, 0
  s_cbranch_scc1 L_po
L_po_ok:
  s_mov_b64 exec, -1
  v_lshrrev_b32 v85, 5, v0
  v_mul_u32_u24 v85, 10240, v85
  v_bfe_u32 v86, v0, 1, 1
  v_lshl_add_u32 v85, v86, 8, v85
  v_bfe_u32 v86, v0, 2, 3
  v_lshl_add_u32 v85, v86, 4, v85
  v_and_b32 v86, 1, v0
  v_lshl_add_u32 v85, v86, 3, v85
  s_mul_i32 s73, s77, 2560
  s_lshr_b32 s74, s78, 3
  s_lshl_b32 s74, s74, 9
  s_add_u32 s73, s73, s74
  s_and_b32 s74, s78, 1
  s_lshl_b32 s74, s74, 7
  s_add_u32 s73, s73, s74
  s_add_u32 s73, s73, 1953792
  buffer_load_dwordx2 v[48:49], v85, s[52:55], s73 offen sc1
  s_add_u32 s73, s73, 20480
  buffer_load_dwordx2 v[50:51], v85, s[52:55], s73 offen sc1
  s_waitcnt vmcnt(0)
  v_add_f32 v48, v48, v50
  v_add_f32 v49, v49, v51
  v_mov_b32 v50, v48
  v_mov_b32 v51, v49
  s_nop 1
  v_permlane32_swap_b32 v48, v50
  v_permlane32_swap_b32 v49, v51
  s_nop 1
  v_add_f32 v48, v48, v50
  v_add_f32 v49, v49, v51
  v_cvt_pk_bf16_f32 v48, v48, v48
  v_lshlrev_b32 v48, 16, v48
  v_mul_f32 v48, v88, v48
  v_cvt_pk_bf16_f32 v48, v48, v48
  v_lshlrev_b32 v48, 16, v48
  v_cvt_pk_bf16_f32 v49, v49, v49
  v_lshlrev_b32 v49, 16, v49
  v_mul_f32 v49, v88, v49
  v_cvt_pk_bf16_f32 v49, v49, v49
  v_lshlrev_b32 v49, 16, v49
  v_lshlrev_b32 v85, 4, v0
  s_lshl_b32 s73, s78, 14
  s_add_u32 s73, s73, 1298432
  s_add_u32 s45, s73, 4096
  s_add_u32 s46, s73, 8192
  s_add_u32 s47, s73, 12288
  s_mov_b32 s44, s73
  v_lshlrev_b32 v91, 2, v0
  s_mul_i32 s74, s77, 1280
  s_lshl_b32 s75, s76, 1
  s_add_u32 s74, s74, s75
  v_mov_b32 v92, 48256
  s_mov_b32 s81, 1048576
L_fw7:
  ds_read_b32 v93, v92 offset:6224
  s_waitcnt lgkmcnt(0)
  v_readfirstlane_b32 s83, v93
  s_nop 0
  s_cmp_ge_u32 s83, 4
  s_cbranch_scc1 L_fw7_ok
  s_sleep 4
  s_sub_u32 s81, s81, 1
  s_cmp_lg_u32 s81, 0
  s_cbranch_scc1 L_fw7
L_fw7_ok:
  s_mov_b32 s81, 262144
L_pollO:
  buffer_load_dwordx4 v[100:103], v85, s[52:55], s44 offen offset:0 sc1
  buffer_load_dwordx4 v[104:107], v85, s[52:55], s44 offen offset:1024 sc1
  buffer_load_dwordx4 v[108:111], v85, s[52:55], s44 offen offset:2048 sc1
  buffer_load_dwordx4 v[112:115], v85, s[52:55], s44 offen offset:3072 sc1
  buffer_load_dwordx4 v[116:119], v85, s[52:55], s45 offen offset:0 sc1
  buffer_load_dwordx4 v[120:123], v85, s[52:55], s45 offen offset:1024 sc1
  buffer_load_dwordx4 v[124:127], v85, s[52:55], s45 offen offset:2048 sc1
  buffer_load_dwordx4 v[128:131], v85, s[52:55], s45 offen offset:3072 sc1
  buffer_load_dwordx4 v[132:135], v85, s[52:55], s46 offen offset:0 sc1
  buffer_load_dwordx4 v[136:139], v85, s[52:55], s46 offen offset:1024 sc1
  buffer_load_dwordx4 v[140:143], v85, s[52:55], s46 offen offset:2048 sc1
  buffer_load_dwordx4 v[144:147], v85, s[52:55], s46 offen offset:3072 sc1
  buffer_load_dwordx4 v[148:151], v85, s[52:55], s47 offen offset:0 sc1
  buffer_load_dwordx4 v[152:155], v85, s[52:55], s47 offen offset:1024 sc1
  buffer_load_dwordx4 v[156:159], v85, s[52:55], s47 offen offset:2048 sc1
  buffer_load_dwordx4 v[160:163], v85, s[52:55], s47 offen offset:3072 sc1
  s_waitcnt vmcnt(0)
  v_min3_u32 v89, v102, v106, v1
  v_max3_u32 v90, v102, v106, v1
  v_min3_u32 v89, v89, v110, v114
  v_max3_u32 v90, v90, v110, v114
  v_min3_u32 v89, v89, v118, v122
  v_max3_u32 v90, v90, v118, v122
  v_min3_u32 v89, v89, v126, v130
  v_max3_u32 v90, v90, v126, v130
  v_min3_u32 v89, v89, v134, v138
  v_max3_u32 v90, v90, v134, v138
  v_min3_u32 v89, v89, v142, v146
  v_max3_u32 v90, v90, v142, v146
  v_min3_u32 v89, v89, v150, v154
  v_max3_u32 v90, v90, v150, v154
  v_min3_u32 v89, v89, v158, v162
  v_max3_u32 v90, v90, v158, v162
  v_cmp_ne_u32 vcc, v89, v90
  s_cbranch_vccz L_pollO_ok
  s_mov_b64 exec, vcc
  s_sub_u32 s81, s81, 1
  s_cmp_lg_u32 s81, 0
  s_cbranch_scc1 L_pollO
L_pollO_ok:
  s_mov_b64 exec, -1
  v_add_f32 v100, v100, v132
  v_add_f32 v101, v101, v133
  v_add_f32 v104, v104, v136
  v_add_f32 v105, v105, v137
  v_add_f32 v108, v108, v140
  v_add_f32 v109, v109, v141
  v_add_f32 v112, v112, v144
  v_add_f32 v113, v113, v145
  v_add_f32 v116, v116, v148
  v_add_f32 v117, v117, v149
  v_add_f32 v120, v120, v152
  v_add_f32 v121, v121, v153
  v_add_f32 v124, v124, v156
  v_add_f32 v125, v125, v157
  v_add_f32 v128, v128, v160
  v_add_f32 v129, v129, v161
  v_add_f32 v100, v100, v116
  v_add_f32 v101, v101, v117
  v_add_f32 v104, v104, v120
  v_add_f32 v105, v105, v121
  v_add_f32 v108, v108, v124
  v_add_f32 v109, v109, v125
  v_add_f32 v112, v112, v128
  v_add_f32 v113, v113, v129
  v_add_f32 v100, v100, v108
  v_add_f32 v101, v101, v109
  v_add_f32 v104, v104, v112
  v_add_f32 v105, v105, v113
  v_add_f32 v100, v100, v104
  v_add_f32 v101, v101, v105
  v_mov_b32 v102, v100
  v_mov_b32 v103, v101
  s_nop 1
  v_permlane32_swap_b32 v100, v102
  v_permlane32_swap_b32 v101, v103
  s_nop 1
  v_add_f32 v100, v100, v102
  v_add_f32 v101, v101, v103
  v_cvt_pk_bf16_f32 v100, v100, v100
  v_lshlrev_b32 v100, 16, v100
  v_cvt_pk_bf16_f32 v101, v101, v101
  v_lshlrev_b32 v101, 16, v101
  v_mul_f32 v100, v87, v100
  v_mul_f32 v101, v87, v101
  v_cvt_pk_bf16_f32 v100, v100, v100
  v_lshlrev_b32 v100, 16, v100
  v_cvt_pk_bf16_f32 v101, v101, v101
  v_lshlrev_b32 v101, 16, v101
  v_add_f32 v100, v100, v48
  v_add_f32 v101, v101, v49
  v_cvt_pk_bf16_f32 v104, v100, v101
  s_mov_b32 exec_hi, 0
  buffer_store_dword v104, v91, s[60:63], s74 offen
  s_cmp_lg_u32 s78, 6
  s_cbranch_scc1 L_fin_done
  s_mov_b64 exec, 1
  buffer_store_dword v1, v5, s[52:55], 0 offen offset:0 sc1
L_fin_done:
  s_mov_b64 exec, -1
L_X_done:
  s_waitcnt lgkmcnt(0)
L_end:
  s_endpgm
.section .rodata,"a"
.p2align 6
.amdhsa_kernel gated_mix__mha_block_cached__glu_gated_swiglu__decode_kernel
  .amdhsa_next_free_vgpr 256
  .amdhsa_next_free_sgpr 102
  .amdhsa_accum_offset 256
  .amdhsa_group_segment_fixed_size 0
  .amdhsa_kernarg_size 104
  .amdhsa_user_sgpr_count 2
  .amdhsa_user_sgpr_kernarg_segment_ptr 1
  .amdhsa_system_sgpr_workgroup_id_x 1
.end_amdhsa_kernel
```
